```python
import torch

def _softmax(x, axis=-1):
    return torch.softmax(x, dim=axis)
def _gelu(x):
    return torch.nn.functional.gelu(x, approximate="tanh")
def _silu(x):
    return torch.nn.functional.silu(x)
def _sigmoid(x):
    return torch.sigmoid(x)
def _layernorm(x, axis=-1, eps=1e-5):
    m = x.mean(dim=axis, keepdim=True)
    v = x.var(dim=axis, keepdim=True, unbiased=False)
    return (x - m) / torch.sqrt(v + eps)
def _scatter_add(tgt, idx, src, axis=0):
    return tgt.clone().index_add_(axis, idx, src)
def _segment_sum(src, seg, n):
    out = torch.zeros((n,) + src.shape[1:], dtype=src.dtype)
    return out.index_add_(0, seg, src)
def _pad(x, pw):
    flat = tuple(v for pair in reversed(pw) for v in pair)
    return torch.nn.functional.pad(x, flat)

kernel_name = 'parallel_sum__sliding_block_cached__glu_gated_reglu__decode'

def setup_inputs():

    _w = (lambda a: (lambda t: t.to(torch.bfloat16) if t.is_floating_point() else t)(torch.as_tensor(a)))
    def _A_setup():
        B, Sq, D = 2, 1, 576
        Hq, Hkv, Sk, Dh = 32, 16, 8192, 128
        assert Hq % Hkv == 0, (Hq, Hkv)
        return {
            "x": _w((lambda *s: torch.randn(*s, dtype=torch.bfloat16) * 0.05)(B, Sq, D)),
            "k_cache": _w((lambda *s: torch.randn(*s, dtype=torch.bfloat16) * 1.6)(B, Hkv, Sk, Dh)),
            "v_cache": _w((lambda *s: torch.randn(*s, dtype=torch.bfloat16) * 0.8)(B, Hkv, Sk, Dh)),
            "wq": _w((lambda *s: torch.randn(*s, dtype=torch.bfloat16) * 1.6)(D, Hq * Dh) * (D ** -0.5)),
            "wo": _w((lambda *s: torch.randn(*s, dtype=torch.bfloat16) * 0.8)(Hq * Dh, D) * ((Hq * Dh) ** -0.5)),
        }
    _A_in = _A_setup()

    def _B_setup():
        B, S, D, F = 2, 1, 576, 4608
        return {
            "x": _w((lambda *s: torch.randn(*s, dtype=torch.bfloat16) * 0.05)(B, S, D)),
            "W_gate": _w((lambda *s: torch.randn(*s, dtype=torch.bfloat16) * 0.4)(D, F) * (2.0 / D) ** 0.5),
            "W_up": _w((lambda *s: torch.randn(*s, dtype=torch.bfloat16) * 0.4)(D, F) * (2.0 / D) ** 0.5),
            "W_down": _w((lambda *s: torch.randn(*s, dtype=torch.bfloat16) * 0.4)(F, D) * (1.0 / F) ** 0.5),
        }
    _B_in = _B_setup()

    return {
        "A_x": _A_in["x"],
        "A_k_cache": _A_in["k_cache"],
        "A_v_cache": _A_in["v_cache"],
        "A_wq": _A_in["wq"],
        "A_wo": _A_in["wo"],
        "B_x": _B_in["x"],
        "B_W_gate": _B_in["W_gate"],
        "B_W_up": _B_in["W_up"],
        "B_W_down": _B_in["W_down"],
    }

def reference(A_x, A_k_cache, A_v_cache, A_wq, A_wo, B_x, B_W_gate, B_W_up, B_W_down):
    def _A_ref(x, k_cache, v_cache, wq, wo):
        B, Sq, D = x.shape
        Hq, Dh = 32, 128
        Hkv, Sk = k_cache.shape[1], k_cache.shape[2]
        W = min(4096, max(256, Sk // 4))
        rep = Hq // Hkv
        q = (lambda x, *d: x.permute(*d))((x @ wq).reshape(B, Sq, Hq, Dh), 0, 2, 1, 3)
        k = (lambda x, n, axis: torch.repeat_interleave(x, n, dim=axis))(k_cache[:, :, Sk - W:, :], rep, axis=1)
        v = (lambda x, n, axis: torch.repeat_interleave(x, n, dim=axis))(v_cache[:, :, Sk - W:, :], rep, axis=1)
        scores = torch.einsum("bhqd,bhkd->bhqk", q, k) * (Dh ** -0.5)
        p = _softmax(scores, axis=-1)
        o = torch.einsum("bhqk,bhkd->bhqd", p, v)
        return (lambda x, *d: x.permute(*d))(o, 0, 2, 1, 3).reshape(B, Sq, Hq * Dh) @ wo

    def _B_ref(x, W_gate, W_up, W_down):
        gate = torch.einsum("bsd,df->bsf", x, W_gate)
        up = torch.einsum("bsd,df->bsf", x, W_up)
        gate = gate * (lambda x, dt: x.to(dt))(gate > 0, gate.dtype)
        h = gate * up
        return torch.einsum("bsf,fd->bsd", h, W_down)

    x = A_x
    xn = _layernorm(x, axis=-1)
    return x + _A_ref(xn, A_k_cache, A_v_cache, A_wq, A_wo) + _B_ref(xn, B_W_gate, B_W_up, B_W_down)
```

```asm
; @launch grid=(256,1,1) block=(704,1,1) lds=162672
.amdgcn_target "amdgcn-amd-amdhsa--gfx950"
.text
.globl parallel_sum__sliding_block_cached__glu_gated_reglu__decode_kernel
.p2align 8
.type parallel_sum__sliding_block_cached__glu_gated_reglu__decode_kernel,@function
parallel_sum__sliding_block_cached__glu_gated_reglu__decode_kernel:
  s_cmp_ge_u32 s2, 256
  s_cbranch_scc1 Lend
  s_load_dwordx16 s[8:23], s[0:1], 0
  s_load_dwordx8 s[24:31], s[0:1], 64
  v_lshrrev_b32 v1, 6, v0
  v_and_b32 v0, 63, v0
  s_and_b32 s32, s2, 7
  v_readfirstlane_b32 s3, v1
  s_lshr_b32 s33, s2, 3
  s_and_b32 s44, s33, 1
  s_lshl_b32 s34, s32, 1
  s_add_u32 s34, s34, s44
  s_lshr_b32 s35, s33, 1
  s_lshr_b32 s36, s35, 3
  s_and_b32 s37, s35, 7
  s_lshr_b32 s44, s33, 3
  s_lshl_b32 s38, s32, 2
  s_add_u32 s38, s38, s44
  s_and_b32 s39, s33, 7
  s_and_b32 s43, s33, 1
  s_lshl_b32 s44, s36, 1
  s_add_u32 s43, s43, s44
  s_and_b32 s34, s33, 15
  s_lshr_b32 s36, s33, 4
  s_add_u32 s37, s32, s33
  s_and_b32 s37, s37, 7
  s_lshl_b32 s35, s36, 3
  s_add_u32 s35, s35, s37
  s_lshr_b32 s43, s33, 3
  s_and_b32 s32, s33, 7
  s_cmp_eq_u32 s37, 0
  s_cselect_b32 s40, 1, 0
  s_cmp_eq_u32 s3, 0
  s_cbranch_scc1 Lloader
  s_cmp_lg_u32 s3, 8
  s_cbranch_scc1 Lpf_1
  s_cmp_ge_u32 s33, 1
  s_cbranch_scc1 Lpf_1
  s_getpc_b64 s[56:57]
Lpf_1_pc:
  s_mov_b32 s58, (Lend-parallel_sum__sliding_block_cached__glu_gated_reglu__decode_kernel)/1024
  s_sub_u32 s56, s56, Lpf_1_pc-parallel_sum__sliding_block_cached__glu_gated_reglu__decode_kernel
  s_subb_u32 s57, s57, 0
  s_add_u32 s56, s56, (Lend-parallel_sum__sliding_block_cached__glu_gated_reglu__decode_kernel)-((Lend-parallel_sum__sliding_block_cached__glu_gated_reglu__decode_kernel)/1024)*1024
  s_addc_u32 s57, s57, 0
  v_lshlrev_b32 v15, 4, v0
Lpf_1_l:
  global_load_dwordx4 v[160:163], v15, s[56:57]
  s_add_u32 s56, s56, 1024
  s_addc_u32 s57, s57, 0
  s_sub_u32 s58, s58, 1
  s_cmp_lg_u32 s58, 0
  s_cbranch_scc1 Lpf_1_l
Lpf_1:
  s_waitcnt lgkmcnt(0)
  s_load_dword s42, s[30:31], 0
  s_mov_b32 s18, 0
  s_mov_b32 s54, 0x3fb8aa3b
  s_mov_b32 s44, s30
  s_mov_b32 s45, s31
  s_mov_b32 s46, 2740224
  s_mov_b32 s47, 0x00020000
  s_waitcnt lgkmcnt(0)
  s_barrier
  s_add_u32 s42, s42, 1
  s_and_b32 s41, s42, 0xfff
  s_cmp_eq_u32 s3, 9
  s_cbranch_scc1 Lqm
  s_cmp_eq_u32 s3, 10
  s_cbranch_scc1 Lm2
  s_branch Lattn
Lloader:
  s_setprio 3
  v_lshrrev_b32 v1, 4, v0
  v_and_b32 v2, 15, v0
  v_lshlrev_b32 v3, 4, v2
  v_lshl_add_u32 v8, v1, 13, v3
  v_add_u32 v9, 31744, v8
  v_add_u32 v10, 63488, v8
  s_mul_i32 s77, s37, 589824
  s_lshl_b32 s99, s34, 9
  s_add_u32 s77, s77, s99
  s_lshl_b32 s99, s36, 8
  s_add_u32 s77, s77, s99
  s_mov_b32 s54, 4718592
  s_mov_b32 s55, 0x00020000
  s_mov_b32 s46, 2304
  s_mov_b32 s47, 0x00020000
  s_mov_b32 m0, 135168
  v_lshlrev_b32 v21, 4, v0
  s_mov_b32 s96, s77
  s_waitcnt lgkmcnt(0)
  s_mov_b32 s44, s8
  s_mov_b32 s45, s9
  s_mov_b32 s52, s14
  s_mov_b32 s53, s15
  buffer_load_dwordx4 v21, s[44:47], 0 offen offset:0 lds
  buffer_load_dwordx4 v21, s[44:47], 0 offen offset:1024 lds
  buffer_load_dwordx4 v21, s[44:47], 0 offen offset:2048 lds
  s_mov_b32 m0, 139264
  s_mov_b32 s18, 0
  buffer_load_dwordx4 v8, s[52:55], s96 offen offset:0 nt lds
  buffer_load_dwordx4 v9, s[52:55], s96 offen offset:1024 nt lds
  buffer_load_dwordx4 v10, s[52:55], s96 offen offset:2048 nt lds
  s_add_u32 m0, m0, 3072
  s_add_u32 s96, s96, 98304
  buffer_load_dwordx4 v8, s[52:55], s96 offen offset:0 nt lds
  buffer_load_dwordx4 v9, s[52:55], s96 offen offset:1024 nt lds
  buffer_load_dwordx4 v10, s[52:55], s96 offen offset:2048 nt lds
  s_add_u32 m0, m0, 3072
  s_add_u32 s96, s96, 98304
  buffer_load_dwordx4 v8, s[52:55], s96 offen offset:0 nt lds
  buffer_load_dwordx4 v9, s[52:55], s96 offen offset:1024 nt lds
  buffer_load_dwordx4 v10, s[52:55], s96 offen offset:2048 nt lds
  s_add_u32 m0, m0, 3072
  s_add_u32 s96, s96, 98304
  buffer_load_dwordx4 v8, s[52:55], s96 offen offset:0 nt lds
  buffer_load_dwordx4 v9, s[52:55], s96 offen offset:1024 nt lds
  buffer_load_dwordx4 v10, s[52:55], s96 offen offset:2048 nt lds
  s_add_u32 m0, m0, 3072
  s_add_u32 s96, s96, 98304
  buffer_load_dwordx4 v8, s[52:55], s96 offen offset:0 nt lds
  buffer_load_dwordx4 v9, s[52:55], s96 offen offset:1024 nt lds
  buffer_load_dwordx4 v10, s[52:55], s96 offen offset:2048 nt lds
  s_add_u32 m0, m0, 3072
  s_add_u32 s96, s96, 98304
  buffer_load_dwordx4 v8, s[52:55], s96 offen offset:0 nt lds
  buffer_load_dwordx4 v9, s[52:55], s96 offen offset:1024 nt lds
  buffer_load_dwordx4 v10, s[52:55], s96 offen offset:2048 nt lds
  v_mov_b32 v4, 162096
  v_mov_b32 v3, 0
  v_lshl_add_u32 v20, v0, 2, v4
  s_mov_b64 exec, 0xffff
  ds_write_b32 v20, v3
  s_mov_b64 exec, -1
  v_lshlrev_b32 v3, 1, v1
  v_xor_b32 v6, v2, v3
  v_lshlrev_b32 v6, 4, v6
  v_lshl_add_u32 v6, v1, 8, v6
  v_add_u32 v3, 8, v3
  v_xor_b32 v7, v2, v3
  v_lshlrev_b32 v7, 4, v7
  v_lshl_add_u32 v7, v1, 8, v7
  s_lshl_b32 s76, s36, 4
  s_add_u32 s76, s76, s34
  s_lshl_b32 s76, s76, 13
  s_add_u32 s76, s76, 6144
  s_mul_i32 s99, s37, 272
  s_sub_u32 s99, s99, 128
  s_cmp_eq_u32 s37, 0
  s_cselect_b32 s99, 0, s99
  s_add_u32 s76, s76, s99
  s_lshl_b32 s76, s76, 8
  s_mul_i32 s7, s2, 37
  s_waitcnt lgkmcnt(0)
  s_mov_b32 s44, s10
  s_mov_b32 s45, s11
  s_mov_b32 s46, 67108864
  s_mov_b32 s47, 0x00020000
  s_mov_b32 s48, s12
  s_mov_b32 s49, s13
  s_mov_b32 s50, 67108864
  s_mov_b32 s51, 0x00020000
  s_cmp_lg_u32 s40, 0
  s_cbranch_scc1 Lheavy_2
  v_mov_b32 v5, -6
  s_and_b32 s100, s7, 15
  s_mov_b32 m0, 0
  s_mov_b32 s98, 1
Lkv_3:
  s_lshl_b32 s96, s100, 12
  s_add_u32 s96, s96, s76
  buffer_load_dwordx4 v6, s[44:47], s96 offen offset:0 nt lds
  buffer_load_dwordx4 v7, s[44:47], s96 offen offset:1024 nt lds
  buffer_load_dwordx4 v6, s[44:47], s96 offen offset:2048 nt lds
  buffer_load_dwordx4 v7, s[44:47], s96 offen offset:3072 nt lds
  s_add_u32 m0, m0, 4096
  s_add_u32 s100, s100, 1
  s_cmp_eq_u32 s100, 17
  s_cselect_b32 s100, 0, s100
  s_waitcnt vmcnt(27)
  v_add_u32 v5, 4, v5
  ds_write_b32 v4, v5 offset:0
  s_sub_u32 s98, s98, 1
  s_cmp_lg_u32 s98, 0
  s_cbranch_scc1 Lkv_3
  s_barrier
  s_mov_b32 s98, s100
  s_mov_b32 s101, m0
  v_lshlrev_b32 v3, 4, v2
  s_movk_i32 s99, 9216
  v_mul_lo_u32 v11, v1, s99
  v_add_u32 v11, v11, v3
  v_add_u32 v12, 35840, v11
  v_add_u32 v13, 71680, v11
  s_movk_i32 s99, 4608
  v_mul_lo_u32 v14, v1, s99
  v_add_u32 v14, v14, v3
  v_add_u32 v15, 128, v14
  v_add_u32 v16, 256, v14
  v_add_u32 v17, 384, v14
  v_lshrrev_b32 v18, 3, v2
  v_lshl_add_u32 v18, v1, 2, v18
  s_movk_i32 s99, 1152
  v_mul_lo_u32 v18, v18, s99
  v_and_b32 v3, 7, v2
  v_lshlrev_b32 v3, 4, v3
  v_add_u32 v18, v18, v3
  v_add_u32 v18, 1024, v18
  v_add_u32 v19, 1280, v18
  s_lshl_b32 s78, s34, 4
  s_add_u32 s78, s78, s35
  s_mul_i32 s78, s78, 18432
  s_mul_i32 s5, s39, 663552
  s_lshl_b32 s99, s38, 8
  s_add_u32 s5, s5, s99
  s_lshl_b32 s6, s38, 3
  s_add_u32 s6, s6, s39
  s_mul_i32 s6, s6, 18432
  s_add_u32 s100, s43, 32
  s_mul_i32 s79, s32, 663552
  s_lshl_b32 s99, s100, 8
  s_add_u32 s79, s79, s99
  s_lshl_b32 s4, s100, 3
  s_add_u32 s4, s4, s32
  s_mul_i32 s4, s4, 18432
  s_mov_b32 s56, s16
  s_mov_b32 s57, s17
  s_mov_b32 s58, 4718592
  s_mov_b32 s59, 0x00020000
  s_mov_b32 s60, s20
  s_mov_b32 s61, s21
  s_mov_b32 s62, 5308416
  s_mov_b32 s63, 0x00020000
  s_mov_b32 s64, s22
  s_mov_b32 s65, s23
  s_mov_b32 s66, 5308416
  s_mov_b32 s67, 0x00020000
  s_mov_b32 s68, s24
  s_mov_b32 s69, s25
  s_mov_b32 s70, 5308416
  s_mov_b32 s71, 0x00020000
  s_mov_b32 s100, s98
  s_mov_b32 m0, s101
  s_mov_b32 s98, 16
Lkv_4:
  s_lshl_b32 s96, s100, 12
  s_add_u32 s96, s96, s76
  buffer_load_dwordx4 v6, s[44:47], s96 offen offset:0 nt lds
  buffer_load_dwordx4 v7, s[44:47], s96 offen offset:1024 nt lds
  buffer_load_dwordx4 v6, s[44:47], s96 offen offset:2048 nt lds
  buffer_load_dwordx4 v7, s[44:47], s96 offen offset:3072 nt lds
  s_add_u32 m0, m0, 4096
  s_add_u32 s100, s100, 1
  s_cmp_eq_u32 s100, 17
  s_cselect_b32 s100, 0, s100
  s_waitcnt vmcnt(27)
  v_add_u32 v5, 4, v5
  ds_write_b32 v4, v5 offset:0
  s_sub_u32 s98, s98, 1
  s_cmp_lg_u32 s98, 0
  s_cbranch_scc1 Lkv_4
Lw1_5:
  s_add_u32 s18, s18, 1
  s_cmp_gt_u32 s18, 4194304
  s_cbranch_scc1 Lend
  ds_read_b32 v3, v4 offset:36
  s_waitcnt lgkmcnt(0)
  v_readfirstlane_b32 s99, v3
  s_cmp_ge_i32 s99, 2
  s_cbranch_scc0 Lw1_5
  s_and_b32 s100, s7, 15
  s_mov_b32 m0, 69632
  s_mov_b32 s98, 14
Lkv_6:
  s_lshl_b32 s96, s100, 12
  s_add_u32 s96, s96, s76
  buffer_load_dwordx4 v6, s[48:51], s96 offen offset:0 nt lds
  buffer_load_dwordx4 v7, s[48:51], s96 offen offset:1024 nt lds
  buffer_load_dwordx4 v6, s[48:51], s96 offen offset:2048 nt lds
  buffer_load_dwordx4 v7, s[48:51], s96 offen offset:3072 nt lds
  s_add_u32 m0, m0, 4096
  s_add_u32 s100, s100, 1
  s_cmp_eq_u32 s100, 17
  s_cselect_b32 s100, 0, s100
  s_waitcnt vmcnt(27)
  v_add_u32 v5, 4, v5
  ds_write_b32 v4, v5 offset:0
  s_sub_u32 s98, s98, 1
  s_cmp_lg_u32 s98, 0
  s_cbranch_scc1 Lkv_6
Lw1_7:
  s_add_u32 s18, s18, 1
  s_cmp_gt_u32 s18, 4194304
  s_cbranch_scc1 Lend
  ds_read_b32 v3, v4 offset:8
  s_waitcnt lgkmcnt(0)
  v_readfirstlane_b32 s99, v3
  s_cmp_ge_i32 s99, 1
  s_cbranch_scc0 Lw1_7
  s_mov_b32 s98, 3
Lkv_8:
  s_lshl_b32 s96, s100, 12
  s_add_u32 s96, s96, s76
  buffer_load_dwordx4 v6, s[48:51], s96 offen offset:0 nt lds
  buffer_load_dwordx4 v7, s[48:51], s96 offen offset:1024 nt lds
  buffer_load_dwordx4 v6, s[48:51], s96 offen offset:2048 nt lds
  buffer_load_dwordx4 v7, s[48:51], s96 offen offset:3072 nt lds
  s_add_u32 m0, m0, 4096
  s_add_u32 s100, s100, 1
  s_cmp_eq_u32 s100, 17
  s_cselect_b32 s100, 0, s100
  s_waitcnt vmcnt(27)
  v_add_u32 v5, 4, v5
  ds_write_b32 v4, v5 offset:0
  s_sub_u32 s98, s98, 1
  s_cmp_lg_u32 s98, 0
  s_cbranch_scc1 Lkv_8
Lw1_9:
  s_add_u32 s18, s18, 1
  s_cmp_gt_u32 s18, 4194304
  s_cbranch_scc1 Lend
  ds_read_b32 v3, v4 offset:4
  s_waitcnt lgkmcnt(0)
  v_readfirstlane_b32 s99, v3
  s_cmp_ge_i32 s99, 1
  s_cbranch_scc0 Lw1_9
  s_mov_b32 s96, s5
  s_mov_b32 m0, 139264
  s_mov_b32 s98, 6
Lcol_10:
  buffer_load_dwordx4 v11, s[60:63], s96 offen offset:0 nt lds
  buffer_load_dwordx4 v12, s[60:63], s96 offen offset:1024 nt lds
  buffer_load_dwordx4 v13, s[60:63], s96 offen offset:2048 nt lds
  s_add_u32 m0, m0, 3072
  s_add_u32 s96, s96, 110592
  s_waitcnt vmcnt(27)
  v_add_u32 v5, 3, v5
  ds_write_b32 v4, v5 offset:0
  s_sub_u32 s98, s98, 1
  s_cmp_lg_u32 s98, 0
  s_cbranch_scc1 Lcol_10
Lw1_11:
  s_add_u32 s18, s18, 1
  s_cmp_gt_u32 s18, 4194304
  s_cbranch_scc1 Lend
  ds_read_b32 v3, v4 offset:32
  s_waitcnt lgkmcnt(0)
  v_readfirstlane_b32 s99, v3
  s_cmp_ge_i32 s99, 8
  s_cbranch_scc0 Lw1_11
  s_mov_b32 s96, s5
  s_mov_b32 m0, 0
  s_mov_b32 s98, 6
Lcol_12:
  buffer_load_dwordx4 v11, s[64:67], s96 offen offset:0 nt lds
  buffer_load_dwordx4 v12, s[64:67], s96 offen offset:1024 nt lds
  buffer_load_dwordx4 v13, s[64:67], s96 offen offset:2048 nt lds
  s_add_u32 m0, m0, 3072
  s_add_u32 s96, s96, 110592
  s_waitcnt vmcnt(27)
  v_add_u32 v5, 3, v5
  ds_write_b32 v4, v5 offset:0
  s_sub_u32 s98, s98, 1
  s_cmp_lg_u32 s98, 0
  s_cbranch_scc1 Lcol_12
  s_mov_b32 s96, s78
  s_mov_b32 m0, 18432
  s_mov_b32 s98, 4
Lrow_13:
  buffer_load_dwordx4 v14, s[56:59], s96 offen offset:0 nt lds
  buffer_load_dwordx4 v15, s[56:59], s96 offen offset:1024 nt lds
  buffer_load_dwordx4 v16, s[56:59], s96 offen offset:2048 nt lds
  buffer_load_dwordx4 v17, s[56:59], s96 offen offset:3072 nt lds
  s_add_u32 m0, m0, 4096
  s_add_u32 s96, s96, 256
  s_waitcnt vmcnt(27)
  v_add_u32 v5, 4, v5
  ds_write_b32 v4, v5 offset:0
  s_sub_u32 s98, s98, 1
  s_cmp_lg_u32 s98, 0
  s_cbranch_scc1 Lrow_13
  buffer_load_dwordx4 v18, s[56:59], s78 offen offset:0 nt lds
  buffer_load_dwordx4 v19, s[56:59], s78 offen offset:1024 nt lds
  s_waitcnt vmcnt(27)
  v_add_u32 v5, 2, v5
  ds_write_b32 v4, v5 offset:0
  s_mov_b32 s96, s6
  s_mov_b32 m0, 36864
  s_mov_b32 s98, 4
Lrow_14:
  buffer_load_dwordx4 v14, s[68:71], s96 offen offset:0 nt lds
  buffer_load_dwordx4 v15, s[68:71], s96 offen offset:1024 nt lds
  buffer_load_dwordx4 v16, s[68:71], s96 offen offset:2048 nt lds
  buffer_load_dwordx4 v17, s[68:71], s96 offen offset:3072 nt lds
  s_add_u32 m0, m0, 4096
  s_add_u32 s96, s96, 256
  s_waitcnt vmcnt(27)
  v_add_u32 v5, 4, v5
  ds_write_b32 v4, v5 offset:0
  s_sub_u32 s98, s98, 1
  s_cmp_lg_u32 s98, 0
  s_cbranch_scc1 Lrow_14
  buffer_load_dwordx4 v18, s[68:71], s6 offen offset:0 nt lds
  buffer_load_dwordx4 v19, s[68:71], s6 offen offset:1024 nt lds
  s_waitcnt vmcnt(27)
  v_add_u32 v5, 2, v5
  ds_write_b32 v4, v5 offset:0
  s_waitcnt vmcnt(23)
  v_mov_b32 v5, 206
  ds_write_b32 v4, v5 offset:0
  s_waitcnt vmcnt(19)
  v_mov_b32 v5, 210
  ds_write_b32 v4, v5 offset:0
  s_waitcnt vmcnt(17)
  v_mov_b32 v5, 212
  ds_write_b32 v4, v5 offset:0
  s_waitcnt vmcnt(15)
  v_mov_b32 v5, 214
  ds_write_b32 v4, v5 offset:0
  s_waitcnt vmcnt(13)
  v_mov_b32 v5, 216
  ds_write_b32 v4, v5 offset:0
  s_waitcnt vmcnt(11)
  v_mov_b32 v5, 218
  ds_write_b32 v4, v5 offset:0
  s_waitcnt vmcnt(9)
  v_mov_b32 v5, 220
  ds_write_b32 v4, v5 offset:0
  s_waitcnt vmcnt(7)
  v_mov_b32 v5, 222
  ds_write_b32 v4, v5 offset:0
  s_waitcnt vmcnt(5)
  v_mov_b32 v5, 224
  ds_write_b32 v4, v5 offset:0
  s_waitcnt vmcnt(3)
  v_mov_b32 v5, 226
  ds_write_b32 v4, v5 offset:0
  s_waitcnt vmcnt(1)
  v_mov_b32 v5, 228
  ds_write_b32 v4, v5 offset:0
  s_waitcnt vmcnt(0)
  v_mov_b32 v5, 229
  ds_write_b32 v4, v5 offset:0
  s_waitcnt lgkmcnt(0)
  s_endpgm
Lheavy_2:
  v_mov_b32 v5, -6
  s_and_b32 s100, s7, 7
  s_mov_b32 m0, 0
  s_mov_b32 s98, 1
Lkv_15:
  s_lshl_b32 s96, s100, 12
  s_add_u32 s96, s96, s76
  buffer_load_dwordx4 v6, s[44:47], s96 offen offset:0 nt lds
  buffer_load_dwordx4 v7, s[44:47], s96 offen offset:1024 nt lds
  buffer_load_dwordx4 v6, s[44:47], s96 offen offset:2048 nt lds
  buffer_load_dwordx4 v7, s[44:47], s96 offen offset:3072 nt lds
  s_add_u32 m0, m0, 4096
  s_add_u32 s100, s100, 1
  s_cmp_eq_u32 s100, 9
  s_cselect_b32 s100, 0, s100
  s_waitcnt vmcnt(27)
  v_add_u32 v5, 4, v5
  ds_write_b32 v4, v5 offset:0
  s_sub_u32 s98, s98, 1
  s_cmp_lg_u32 s98, 0
  s_cbranch_scc1 Lkv_15
  s_barrier
  s_mov_b32 s98, s100
  s_mov_b32 s101, m0
  v_lshlrev_b32 v3, 4, v2
  s_movk_i32 s99, 9216
  v_mul_lo_u32 v11, v1, s99
  v_add_u32 v11, v11, v3
  v_add_u32 v12, 35840, v11
  v_add_u32 v13, 71680, v11
  s_movk_i32 s99, 4608
  v_mul_lo_u32 v14, v1, s99
  v_add_u32 v14, v14, v3
  v_add_u32 v15, 128, v14
  v_add_u32 v16, 256, v14
  v_add_u32 v17, 384, v14
  v_lshrrev_b32 v18, 3, v2
  v_lshl_add_u32 v18, v1, 2, v18
  s_movk_i32 s99, 1152
  v_mul_lo_u32 v18, v18, s99
  v_and_b32 v3, 7, v2
  v_lshlrev_b32 v3, 4, v3
  v_add_u32 v18, v18, v3
  v_add_u32 v18, 1024, v18
  v_add_u32 v19, 1280, v18
  s_lshl_b32 s78, s34, 4
  s_add_u32 s78, s78, s35
  s_mul_i32 s78, s78, 18432
  s_mul_i32 s5, s39, 663552
  s_lshl_b32 s99, s38, 8
  s_add_u32 s5, s5, s99
  s_lshl_b32 s6, s38, 3
  s_add_u32 s6, s6, s39
  s_mul_i32 s6, s6, 18432
  s_add_u32 s100, s43, 32
  s_mul_i32 s79, s32, 663552
  s_lshl_b32 s99, s100, 8
  s_add_u32 s79, s79, s99
  s_lshl_b32 s4, s100, 3
  s_add_u32 s4, s4, s32
  s_mul_i32 s4, s4, 18432
  s_mov_b32 s56, s16
  s_mov_b32 s57, s17
  s_mov_b32 s58, 4718592
  s_mov_b32 s59, 0x00020000
  s_mov_b32 s60, s20
  s_mov_b32 s61, s21
  s_mov_b32 s62, 5308416
  s_mov_b32 s63, 0x00020000
  s_mov_b32 s64, s22
  s_mov_b32 s65, s23
  s_mov_b32 s66, 5308416
  s_mov_b32 s67, 0x00020000
  s_mov_b32 s68, s24
  s_mov_b32 s69, s25
  s_mov_b32 s70, 5308416
  s_mov_b32 s71, 0x00020000
  s_mov_b32 s100, s98
  s_mov_b32 m0, s101
  s_mov_b32 s98, 8
Lkv_16:
  s_lshl_b32 s96, s100, 12
  s_add_u32 s96, s96, s76
  buffer_load_dwordx4 v6, s[44:47], s96 offen offset:0 nt lds
  buffer_load_dwordx4 v7, s[44:47], s96 offen offset:1024 nt lds
  buffer_load_dwordx4 v6, s[44:47], s96 offen offset:2048 nt lds
  buffer_load_dwordx4 v7, s[44:47], s96 offen offset:3072 nt lds
  s_add_u32 m0, m0, 4096
  s_add_u32 s100, s100, 1
  s_cmp_eq_u32 s100, 9
  s_cselect_b32 s100, 0, s100
  s_waitcnt vmcnt(27)
  v_add_u32 v5, 4, v5
  ds_write_b32 v4, v5 offset:0
  s_sub_u32 s98, s98, 1
  s_cmp_lg_u32 s98, 0
  s_cbranch_scc1 Lkv_16
  v_subrev_u32 v5, 6, v5
Lw1_17:
  s_add_u32 s18, s18, 1
  s_cmp_gt_u32 s18, 4194304
  s_cbranch_scc1 Lend
  ds_read_b32 v3, v4 offset:36
  s_waitcnt lgkmcnt(0)
  v_readfirstlane_b32 s99, v3
  s_cmp_ge_i32 s99, 2
  s_cbranch_scc0 Lw1_17
  s_and_b32 s100, s7, 7
  s_mov_b32 m0, 69632
  s_mov_b32 s98, 9
Lkv_18:
  s_lshl_b32 s96, s100, 12
  s_add_u32 s96, s96, s76
  buffer_load_dwordx4 v6, s[48:51], s96 offen offset:0 nt lds
  buffer_load_dwordx4 v7, s[48:51], s96 offen offset:1024 nt lds
  buffer_load_dwordx4 v6, s[48:51], s96 offen offset:2048 nt lds
  buffer_load_dwordx4 v7, s[48:51], s96 offen offset:3072 nt lds
  s_add_u32 m0, m0, 4096
  s_add_u32 s100, s100, 1
  s_cmp_eq_u32 s100, 9
  s_cselect_b32 s100, 0, s100
  s_waitcnt vmcnt(33)
  v_add_u32 v5, 4, v5
  ds_write_b32 v4, v5 offset:0
  s_sub_u32 s98, s98, 1
  s_cmp_lg_u32 s98, 0
  s_cbranch_scc1 Lkv_18
Lw1_19:
  s_add_u32 s18, s18, 1
  s_cmp_gt_u32 s18, 4194304
  s_cbranch_scc1 Lend
  ds_read_b32 v3, v4 offset:4
  s_waitcnt lgkmcnt(0)
  v_readfirstlane_b32 s99, v3
  s_cmp_ge_i32 s99, 1
  s_cbranch_scc0 Lw1_19
  s_mov_b32 s96, s79
  s_mov_b32 m0, 139264
  s_mov_b32 s98, 6
Lcol_20:
  buffer_load_dwordx4 v11, s[60:63], s96 offen offset:0 nt lds
  buffer_load_dwordx4 v12, s[60:63], s96 offen offset:1024 nt lds
  buffer_load_dwordx4 v13, s[60:63], s96 offen offset:2048 nt lds
  s_add_u32 m0, m0, 3072
  s_add_u32 s96, s96, 110592
  s_waitcnt vmcnt(33)
  v_add_u32 v5, 3, v5
  ds_write_b32 v4, v5 offset:0
  s_sub_u32 s98, s98, 1
  s_cmp_lg_u32 s98, 0
  s_cbranch_scc1 Lcol_20
Lw1_21:
  s_add_u32 s18, s18, 1
  s_cmp_gt_u32 s18, 4194304
  s_cbranch_scc1 Lend
  ds_read_b32 v3, v4 offset:32
  s_waitcnt lgkmcnt(0)
  v_readfirstlane_b32 s99, v3
  s_cmp_ge_i32 s99, 8
  s_cbranch_scc0 Lw1_21
  s_mov_b32 s96, s79
  s_mov_b32 m0, 0
  s_mov_b32 s98, 6
Lcol_22:
  buffer_load_dwordx4 v11, s[64:67], s96 offen offset:0 nt lds
  buffer_load_dwordx4 v12, s[64:67], s96 offen offset:1024 nt lds
  buffer_load_dwordx4 v13, s[64:67], s96 offen offset:2048 nt lds
  s_add_u32 m0, m0, 3072
  s_add_u32 s96, s96, 110592
  s_waitcnt vmcnt(33)
  v_add_u32 v5, 3, v5
  ds_write_b32 v4, v5 offset:0
  s_sub_u32 s98, s98, 1
  s_cmp_lg_u32 s98, 0
  s_cbranch_scc1 Lcol_22
  s_mov_b32 s96, s5
  s_mov_b32 m0, 18432
  s_mov_b32 s98, 6
Lcol_23:
  buffer_load_dwordx4 v11, s[60:63], s96 offen offset:0 nt lds
  buffer_load_dwordx4 v12, s[60:63], s96 offen offset:1024 nt lds
  buffer_load_dwordx4 v13, s[60:63], s96 offen offset:2048 nt lds
  s_add_u32 m0, m0, 3072
  s_add_u32 s96, s96, 110592
  s_waitcnt vmcnt(33)
  v_add_u32 v5, 3, v5
  ds_write_b32 v4, v5 offset:0
  s_sub_u32 s98, s98, 1
  s_cmp_lg_u32 s98, 0
  s_cbranch_scc1 Lcol_23
  s_mov_b32 s96, s5
  s_mov_b32 m0, 36864
  s_mov_b32 s98, 6
Lcol_24:
  buffer_load_dwordx4 v11, s[64:67], s96 offen offset:0 nt lds
  buffer_load_dwordx4 v12, s[64:67], s96 offen offset:1024 nt lds
  buffer_load_dwordx4 v13, s[64:67], s96 offen offset:2048 nt lds
  s_add_u32 m0, m0, 3072
  s_add_u32 s96, s96, 110592
  s_waitcnt vmcnt(33)
  v_add_u32 v5, 3, v5
  ds_write_b32 v4, v5 offset:0
  s_sub_u32 s98, s98, 1
  s_cmp_lg_u32 s98, 0
  s_cbranch_scc1 Lcol_24
  s_mov_b32 s96, s78
  s_mov_b32 m0, 106496
  s_mov_b32 s98, 4
Lrow_25:
  buffer_load_dwordx4 v14, s[56:59], s96 offen offset:0 nt lds
  buffer_load_dwordx4 v15, s[56:59], s96 offen offset:1024 nt lds
  buffer_load_dwordx4 v16, s[56:59], s96 offen offset:2048 nt lds
  buffer_load_dwordx4 v17, s[56:59], s96 offen offset:3072 nt lds
  s_add_u32 m0, m0, 4096
  s_add_u32 s96, s96, 256
  s_waitcnt vmcnt(33)
  v_add_u32 v5, 4, v5
  ds_write_b32 v4, v5 offset:0
  s_sub_u32 s98, s98, 1
  s_cmp_lg_u32 s98, 0
  s_cbranch_scc1 Lrow_25
  buffer_load_dwordx4 v18, s[56:59], s78 offen offset:0 nt lds
  buffer_load_dwordx4 v19, s[56:59], s78 offen offset:1024 nt lds
  s_waitcnt vmcnt(33)
  v_add_u32 v5, 2, v5
  ds_write_b32 v4, v5 offset:0
Lw1_26:
  s_add_u32 s18, s18, 1
  s_cmp_gt_u32 s18, 4194304
  s_cbranch_scc1 Lend
  ds_read_b32 v3, v4 offset:20
  s_waitcnt lgkmcnt(0)
  v_readfirstlane_b32 s99, v3
  s_cmp_ge_i32 s99, 8
  s_cbranch_scc0 Lw1_26
  s_mov_b32 s96, s4
  s_mov_b32 m0, 69632
  s_mov_b32 s98, 4
Lrow_27:
  buffer_load_dwordx4 v14, s[68:71], s96 offen offset:0 nt lds
  buffer_load_dwordx4 v15, s[68:71], s96 offen offset:1024 nt lds
  buffer_load_dwordx4 v16, s[68:71], s96 offen offset:2048 nt lds
  buffer_load_dwordx4 v17, s[68:71], s96 offen offset:3072 nt lds
  s_add_u32 m0, m0, 4096
  s_add_u32 s96, s96, 256
  s_waitcnt vmcnt(33)
  v_add_u32 v5, 4, v5
  ds_write_b32 v4, v5 offset:0
  s_sub_u32 s98, s98, 1
  s_cmp_lg_u32 s98, 0
  s_cbranch_scc1 Lrow_27
  buffer_load_dwordx4 v18, s[68:71], s4 offen offset:0 nt lds
  buffer_load_dwordx4 v19, s[68:71], s4 offen offset:1024 nt lds
  s_waitcnt vmcnt(33)
  v_add_u32 v5, 2, v5
  ds_write_b32 v4, v5 offset:0
  s_mov_b32 s96, s6
  s_mov_b32 m0, 88064
  s_mov_b32 s98, 4
Lrow_28:
  buffer_load_dwordx4 v14, s[68:71], s96 offen offset:0 nt lds
  buffer_load_dwordx4 v15, s[68:71], s96 offen offset:1024 nt lds
  buffer_load_dwordx4 v16, s[68:71], s96 offen offset:2048 nt lds
  buffer_load_dwordx4 v17, s[68:71], s96 offen offset:3072 nt lds
  s_add_u32 m0, m0, 4096
  s_add_u32 s96, s96, 256
  s_waitcnt vmcnt(33)
  v_add_u32 v5, 4, v5
  ds_write_b32 v4, v5 offset:0
  s_sub_u32 s98, s98, 1
  s_cmp_lg_u32 s98, 0
  s_cbranch_scc1 Lrow_28
  buffer_load_dwordx4 v18, s[68:71], s6 offen offset:0 nt lds
  buffer_load_dwordx4 v19, s[68:71], s6 offen offset:1024 nt lds
  s_waitcnt vmcnt(33)
  v_add_u32 v5, 2, v5
  ds_write_b32 v4, v5 offset:0
  s_waitcnt vmcnt(29)
  v_mov_b32 v5, 190
  ds_write_b32 v4, v5 offset:0
  s_waitcnt vmcnt(25)
  v_mov_b32 v5, 194
  ds_write_b32 v4, v5 offset:0
  s_waitcnt vmcnt(21)
  v_mov_b32 v5, 198
  ds_write_b32 v4, v5 offset:0
  s_waitcnt vmcnt(17)
  v_mov_b32 v5, 202
  ds_write_b32 v4, v5 offset:0
  s_waitcnt vmcnt(15)
  v_mov_b32 v5, 204
  ds_write_b32 v4, v5 offset:0
  s_waitcnt vmcnt(13)
  v_mov_b32 v5, 206
  ds_write_b32 v4, v5 offset:0
  s_waitcnt vmcnt(11)
  v_mov_b32 v5, 208
  ds_write_b32 v4, v5 offset:0
  s_waitcnt vmcnt(9)
  v_mov_b32 v5, 210
  ds_write_b32 v4, v5 offset:0
  s_waitcnt vmcnt(7)
  v_mov_b32 v5, 212
  ds_write_b32 v4, v5 offset:0
  s_waitcnt vmcnt(5)
  v_mov_b32 v5, 214
  ds_write_b32 v4, v5 offset:0
  s_waitcnt vmcnt(3)
  v_mov_b32 v5, 216
  ds_write_b32 v4, v5 offset:0
  s_waitcnt vmcnt(1)
  v_mov_b32 v5, 218
  ds_write_b32 v4, v5 offset:0
  s_waitcnt vmcnt(0)
  v_mov_b32 v5, 219
  ds_write_b32 v4, v5 offset:0
  s_waitcnt lgkmcnt(0)
  s_endpgm
Lm2:
  v_mov_b32 v1, 162096
  v_mov_b32 v2, 1
  s_mov_b32 s52, -1000
  s_sub_u32 s57, s3, 9
  s_mul_i32 s53, s57, 1152
  s_add_u32 s53, s53, 135168
  v_lshlrev_b32 v19, 2, v0
  v_add_u32 v39, s53, v19
  s_mul_i32 s53, s57, 1160
  s_add_u32 s53, s53, 157696
  v_add_u32 v38, s53, v19
  s_mov_b32 s58, -1
  s_mov_b32 s59, 0
Lwf_29:
  s_cmp_ge_i32 s52, 3
  s_cbranch_scc1 Lwfd_30
  s_add_u32 s18, s18, 1
  s_cmp_gt_u32 s18, 4194304
  s_cbranch_scc1 Lend
  ds_read_b32 v3, v1 offset:0
  s_waitcnt lgkmcnt(0)
  v_readfirstlane_b32 s52, v3
  s_branch Lwf_29
Lwfd_30:
  ds_read_b32 v10, v39 offset:0
  ds_read_b32 v11, v39 offset:256
  ds_read_b32 v12, v39 offset:512
  ds_read_b32 v13, v39 offset:768
  ds_read_b32 v14, v39 offset:1024
  s_waitcnt lgkmcnt(0)
  v_cndmask_b32 v14, 0, v14, s[58:59]
  v_lshlrev_b32 v90, 16, v10
  v_and_b32 v91, 0xffff0000, v10
  v_lshlrev_b32 v92, 16, v11
  v_and_b32 v93, 0xffff0000, v11
  v_lshlrev_b32 v94, 16, v12
  v_and_b32 v95, 0xffff0000, v12
  v_lshlrev_b32 v96, 16, v13
  v_and_b32 v97, 0xffff0000, v13
  v_lshlrev_b32 v98, 16, v14
  v_and_b32 v99, 0xffff0000, v14
  v_add_f32 v40, v90, v91
  v_add_f32 v44, v92, v93
  v_add_f32 v45, v94, v95
  v_add_f32 v46, v96, v97
  v_add_f32 v47, v98, v99
  v_add_f32 v40, v40, v44
  v_add_f32 v45, v45, v46
  v_add_f32 v40, v40, v47
  v_add_f32 v40, v40, v45
  s_nop 1
  v_add_f32_dpp v40, v40, v40 quad_perm:[1,0,3,2] row_mask:0xf bank_mask:0xf
  s_nop 1
  v_add_f32_dpp v40, v40, v40 quad_perm:[2,3,0,1] row_mask:0xf bank_mask:0xf
  s_nop 1
  v_add_f32_dpp v40, v40, v40 row_half_mirror row_mask:0xf bank_mask:0xf
  s_nop 1
  v_add_f32_dpp v40, v40, v40 row_mirror row_mask:0xf bank_mask:0xf
  v_mov_b32 v41, v40
  s_nop 1
  v_permlane16_swap_b32 v40, v41
  s_nop 1
  v_add_f32 v40, v40, v41
  v_mov_b32 v41, v40
  s_nop 1
  v_permlane32_swap_b32 v40, v41
  s_nop 1
  v_add_f32 v40, v40, v41
  v_mul_f32 v42, 0x3ae38e39, v40
  v_sub_f32 v60, v90, v42
  v_sub_f32 v61, v91, v42
  v_sub_f32 v62, v92, v42
  v_sub_f32 v63, v93, v42
  v_sub_f32 v64, v94, v42
  v_sub_f32 v65, v95, v42
  v_sub_f32 v66, v96, v42
  v_sub_f32 v67, v97, v42
  v_sub_f32 v68, v98, v42
  v_sub_f32 v69, v99, v42
  v_cndmask_b32 v68, 0, v68, s[58:59]
  v_cndmask_b32 v69, 0, v69, s[58:59]
  v_mul_f32 v40, v60, v60
  v_mul_f32 v44, v61, v61
  v_fmac_f32 v40, v62, v62
  v_fmac_f32 v44, v63, v63
  v_fmac_f32 v40, v64, v64
  v_fmac_f32 v44, v65, v65
  v_fmac_f32 v40, v66, v66
  v_fmac_f32 v44, v67, v67
  v_fmac_f32 v40, v68, v68
  v_fmac_f32 v44, v69, v69
  v_add_f32 v40, v40, v44
  s_nop 1
  v_add_f32_dpp v40, v40, v40 quad_perm:[1,0,3,2] row_mask:0xf bank_mask:0xf
  s_nop 1
  v_add_f32_dpp v40, v40, v40 quad_perm:[2,3,0,1] row_mask:0xf bank_mask:0xf
  s_nop 1
  v_add_f32_dpp v40, v40, v40 row_half_mirror row_mask:0xf bank_mask:0xf
  s_nop 1
  v_add_f32_dpp v40, v40, v40 row_mirror row_mask:0xf bank_mask:0xf
  v_mov_b32 v41, v40
  s_nop 1
  v_permlane16_swap_b32 v40, v41
  s_nop 1
  v_add_f32 v40, v40, v41
  v_mov_b32 v41, v40
  s_nop 1
  v_permlane32_swap_b32 v40, v41
  s_nop 1
  v_add_f32 v40, v40, v41
  v_mul_f32 v43, 0x3ae38e39, v40
  v_cvt_pk_bf16_f32 v43, v43, v42
  v_and_b32 v42, 0xffff0000, v43
  v_lshlrev_b32 v43, 16, v43
  v_add_f32 v43, 0x3727c5ac, v43
  v_cvt_pk_bf16_f32 v43, v43, v43
  v_and_b32 v43, 0xffff0000, v43
  v_sqrt_f32 v43, v43
  s_nop 0
  v_cvt_pk_bf16_f32 v43, v43, v43
  v_and_b32 v43, 0xffff0000, v43
  v_rcp_f32 v43, v43
  v_sub_f32 v90, v90, v42
  v_sub_f32 v91, v91, v42
  v_sub_f32 v92, v92, v42
  v_sub_f32 v93, v93, v42
  v_sub_f32 v94, v94, v42
  v_sub_f32 v95, v95, v42
  v_sub_f32 v96, v96, v42
  v_sub_f32 v97, v97, v42
  v_sub_f32 v98, v98, v42
  v_sub_f32 v99, v99, v42
  v_cvt_pk_bf16_f32 v60, v90, v91
  v_cvt_pk_bf16_f32 v61, v92, v93
  v_cvt_pk_bf16_f32 v62, v94, v95
  v_cvt_pk_bf16_f32 v63, v96, v97
  v_cvt_pk_bf16_f32 v64, v98, v99
  v_lshlrev_b32 v90, 16, v60
  v_and_b32 v91, 0xffff0000, v60
  v_lshlrev_b32 v92, 16, v61
  v_and_b32 v93, 0xffff0000, v61
  v_lshlrev_b32 v94, 16, v62
  v_and_b32 v95, 0xffff0000, v62
  v_lshlrev_b32 v96, 16, v63
  v_and_b32 v97, 0xffff0000, v63
  v_lshlrev_b32 v98, 16, v64
  v_and_b32 v99, 0xffff0000, v64
  v_mul_f32 v90, v90, v43
  v_mul_f32 v91, v91, v43
  v_mul_f32 v92, v92, v43
  v_mul_f32 v93, v93, v43
  v_mul_f32 v94, v94, v43
  v_mul_f32 v95, v95, v43
  v_mul_f32 v96, v96, v43
  v_mul_f32 v97, v97, v43
  v_mul_f32 v98, v98, v43
  v_mul_f32 v99, v99, v43
  v_cvt_pk_bf16_f32 v60, v90, v91
  v_cvt_pk_bf16_f32 v61, v92, v93
  v_cvt_pk_bf16_f32 v62, v94, v95
  v_cvt_pk_bf16_f32 v63, v96, v97
  v_cvt_pk_bf16_f32 v64, v98, v99
  ds_write_b32 v38, v60 offset:0
  ds_write_b32 v38, v61 offset:256
  ds_write_b32 v38, v62 offset:512
  ds_write_b32 v38, v63 offset:768
  s_mov_b32 exec_hi, 0
  ds_write_b32 v38, v64 offset:1024
  s_mov_b64 exec, -1
  s_waitcnt lgkmcnt(0)
  s_mov_b64 exec, 1
  ds_add_u32 v1, v2 offset:36
  s_mov_b64 exec, -1
  s_cmp_eq_u32 s40, 0
  s_cbranch_scc1 Lend
  v_mov_b32 v1, 162096
  v_mov_b32 v2, 1
  s_mov_b32 s52, -1000
  v_and_b32 v3, 1, v0
  v_mov_b32 v38, 0xffff
  v_lshlrev_b32 v3, 4, v3
  v_lshlrev_b32 v38, v3, v38
  v_bfe_u32 v3, v0, 1, 2
  v_cmp_eq_u32 vcc, 0, v3
  s_nop 1
  v_cndmask_b32 v4, 0, v38, vcc
  v_cmp_eq_u32 vcc, 1, v3
  s_nop 1
  v_cndmask_b32 v5, 0, v38, vcc
  v_cmp_eq_u32 vcc, 2, v3
  s_nop 1
  v_cndmask_b32 v6, 0, v38, vcc
  v_cmp_eq_u32 vcc, 3, v3
  s_nop 1
  v_cndmask_b32 v7, 0, v38, vcc
  v_mov_b32 v8, s41
  v_and_b32 v9, 0xff, v8
  v_lshrrev_b32 v12, 4, v0
  v_bfe_u32 v13, v0, 3, 1
  s_movk_i32 s53, 1160
  v_mul_lo_u32 v14, v13, s53
  v_lshl_add_u32 v14, v12, 1, v14
  v_add_u32 v14, 157696, v14
  v_lshlrev_b32 v15, 4, v0
  s_mov_b32 s60, 139264
  s_mov_b32 s61, 0
  s_mov_b32 s62, 111
  s_add_u32 s63, s43, 32
  s_mov_b32 s64, s32
  s_lshl_b32 s53, s43, 3
  s_add_u32 s65, s53, s32
  s_add_u32 s65, s65, 256
  s_mov_b32 s66, 0
  s_mov_b32 s67, 69632
  s_mov_b32 s68, 183
  s_mov_b32 s69, 161968
Lw1_31:
  s_add_u32 s18, s18, 1
  s_cmp_gt_u32 s18, 4194304
  s_cbranch_scc1 Lend
  ds_read_b32 v3, v1 offset:36
  s_waitcnt lgkmcnt(0)
  v_readfirstlane_b32 s53, v3
  s_cmp_ge_i32 s53, 2
  s_cbranch_scc0 Lw1_31
  s_branch Lmphase
Lqm:
  v_lshrrev_b32 v3, 5, v0
  s_movk_i32 s53, 1152
  v_mul_lo_u32 v39, v3, s53
  v_and_b32 v19, 31, v0
  v_lshl_add_u32 v39, v19, 2, v39
  v_add_u32 v39, 135168, v39
  v_mov_b32 v1, 162096
  v_mov_b32 v2, 1
  s_mov_b32 s52, -1000
  v_and_b32 v3, 1, v0
  v_mov_b32 v38, 0xffff
  v_lshlrev_b32 v3, 4, v3
  v_lshlrev_b32 v38, v3, v38
  v_bfe_u32 v3, v0, 1, 2
  v_cmp_eq_u32 vcc, 0, v3
  s_nop 1
  v_cndmask_b32 v4, 0, v38, vcc
  v_cmp_eq_u32 vcc, 1, v3
  s_nop 1
  v_cndmask_b32 v5, 0, v38, vcc
  v_cmp_eq_u32 vcc, 2, v3
  s_nop 1
  v_cndmask_b32 v6, 0, v38, vcc
  v_cmp_eq_u32 vcc, 3, v3
  s_nop 1
  v_cndmask_b32 v7, 0, v38, vcc
  v_mov_b32 v8, s41
  v_and_b32 v9, 0xff, v8
  s_sub_u32 s57, s3, 9
  s_mul_i32 s53, s57, 1152
  s_add_u32 s53, s53, 135168
  v_lshlrev_b32 v19, 2, v0
  v_add_u32 v39, s53, v19
  s_mul_i32 s53, s57, 1160
  s_add_u32 s53, s53, 157696
  v_add_u32 v38, s53, v19
  s_mov_b32 s58, -1
  s_mov_b32 s59, 0
Lwf_32:
  s_cmp_ge_i32 s52, 3
  s_cbranch_scc1 Lwfd_33
  s_add_u32 s18, s18, 1
  s_cmp_gt_u32 s18, 4194304
  s_cbranch_scc1 Lend
  ds_read_b32 v3, v1 offset:0
  s_waitcnt lgkmcnt(0)
  v_readfirstlane_b32 s52, v3
  s_branch Lwf_32
Lwfd_33:
  ds_read_b32 v10, v39 offset:0
  ds_read_b32 v11, v39 offset:256
  ds_read_b32 v12, v39 offset:512
  ds_read_b32 v13, v39 offset:768
  ds_read_b32 v14, v39 offset:1024
  s_waitcnt lgkmcnt(0)
  v_cndmask_b32 v14, 0, v14, s[58:59]
  v_lshlrev_b32 v90, 16, v10
  v_and_b32 v91, 0xffff0000, v10
  v_lshlrev_b32 v92, 16, v11
  v_and_b32 v93, 0xffff0000, v11
  v_lshlrev_b32 v94, 16, v12
  v_and_b32 v95, 0xffff0000, v12
  v_lshlrev_b32 v96, 16, v13
  v_and_b32 v97, 0xffff0000, v13
  v_lshlrev_b32 v98, 16, v14
  v_and_b32 v99, 0xffff0000, v14
  v_add_f32 v40, v90, v91
  v_add_f32 v44, v92, v93
  v_add_f32 v45, v94, v95
  v_add_f32 v46, v96, v97
  v_add_f32 v47, v98, v99
  v_add_f32 v40, v40, v44
  v_add_f32 v45, v45, v46
  v_add_f32 v40, v40, v47
  v_add_f32 v40, v40, v45
  s_nop 1
  v_add_f32_dpp v40, v40, v40 quad_perm:[1,0,3,2] row_mask:0xf bank_mask:0xf
  s_nop 1
  v_add_f32_dpp v40, v40, v40 quad_perm:[2,3,0,1] row_mask:0xf bank_mask:0xf
  s_nop 1
  v_add_f32_dpp v40, v40, v40 row_half_mirror row_mask:0xf bank_mask:0xf
  s_nop 1
  v_add_f32_dpp v40, v40, v40 row_mirror row_mask:0xf bank_mask:0xf
  v_mov_b32 v41, v40
  s_nop 1
  v_permlane16_swap_b32 v40, v41
  s_nop 1
  v_add_f32 v40, v40, v41
  v_mov_b32 v41, v40
  s_nop 1
  v_permlane32_swap_b32 v40, v41
  s_nop 1
  v_add_f32 v40, v40, v41
  v_mul_f32 v42, 0x3ae38e39, v40
  v_sub_f32 v60, v90, v42
  v_sub_f32 v61, v91, v42
  v_sub_f32 v62, v92, v42
  v_sub_f32 v63, v93, v42
  v_sub_f32 v64, v94, v42
  v_sub_f32 v65, v95, v42
  v_sub_f32 v66, v96, v42
  v_sub_f32 v67, v97, v42
  v_sub_f32 v68, v98, v42
  v_sub_f32 v69, v99, v42
  v_cndmask_b32 v68, 0, v68, s[58:59]
  v_cndmask_b32 v69, 0, v69, s[58:59]
  v_mul_f32 v40, v60, v60
  v_mul_f32 v44, v61, v61
  v_fmac_f32 v40, v62, v62
  v_fmac_f32 v44, v63, v63
  v_fmac_f32 v40, v64, v64
  v_fmac_f32 v44, v65, v65
  v_fmac_f32 v40, v66, v66
  v_fmac_f32 v44, v67, v67
  v_fmac_f32 v40, v68, v68
  v_fmac_f32 v44, v69, v69
  v_add_f32 v40, v40, v44
  s_nop 1
  v_add_f32_dpp v40, v40, v40 quad_perm:[1,0,3,2] row_mask:0xf bank_mask:0xf
  s_nop 1
  v_add_f32_dpp v40, v40, v40 quad_perm:[2,3,0,1] row_mask:0xf bank_mask:0xf
  s_nop 1
  v_add_f32_dpp v40, v40, v40 row_half_mirror row_mask:0xf bank_mask:0xf
  s_nop 1
  v_add_f32_dpp v40, v40, v40 row_mirror row_mask:0xf bank_mask:0xf
  v_mov_b32 v41, v40
  s_nop 1
  v_permlane16_swap_b32 v40, v41
  s_nop 1
  v_add_f32 v40, v40, v41
  v_mov_b32 v41, v40
  s_nop 1
  v_permlane32_swap_b32 v40, v41
  s_nop 1
  v_add_f32 v40, v40, v41
  v_mul_f32 v43, 0x3ae38e39, v40
  v_cvt_pk_bf16_f32 v43, v43, v42
  v_and_b32 v42, 0xffff0000, v43
  v_lshlrev_b32 v43, 16, v43
  v_add_f32 v43, 0x3727c5ac, v43
  v_cvt_pk_bf16_f32 v43, v43, v43
  v_and_b32 v43, 0xffff0000, v43
  v_sqrt_f32 v43, v43
  s_nop 0
  v_cvt_pk_bf16_f32 v43, v43, v43
  v_and_b32 v43, 0xffff0000, v43
  v_rcp_f32 v43, v43
  v_sub_f32 v90, v90, v42
  v_sub_f32 v91, v91, v42
  v_sub_f32 v92, v92, v42
  v_sub_f32 v93, v93, v42
  v_sub_f32 v94, v94, v42
  v_sub_f32 v95, v95, v42
  v_sub_f32 v96, v96, v42
  v_sub_f32 v97, v97, v42
  v_sub_f32 v98, v98, v42
  v_sub_f32 v99, v99, v42
  v_cvt_pk_bf16_f32 v60, v90, v91
  v_cvt_pk_bf16_f32 v61, v92, v93
  v_cvt_pk_bf16_f32 v62, v94, v95
  v_cvt_pk_bf16_f32 v63, v96, v97
  v_cvt_pk_bf16_f32 v64, v98, v99
  v_lshlrev_b32 v90, 16, v60
  v_and_b32 v91, 0xffff0000, v60
  v_lshlrev_b32 v92, 16, v61
  v_and_b32 v93, 0xffff0000, v61
  v_lshlrev_b32 v94, 16, v62
  v_and_b32 v95, 0xffff0000, v62
  v_lshlrev_b32 v96, 16, v63
  v_and_b32 v97, 0xffff0000, v63
  v_lshlrev_b32 v98, 16, v64
  v_and_b32 v99, 0xffff0000, v64
  v_mul_f32 v90, v90, v43
  v_mul_f32 v91, v91, v43
  v_mul_f32 v92, v92, v43
  v_mul_f32 v93, v93, v43
  v_mul_f32 v94, v94, v43
  v_mul_f32 v95, v95, v43
  v_mul_f32 v96, v96, v43
  v_mul_f32 v97, v97, v43
  v_mul_f32 v98, v98, v43
  v_mul_f32 v99, v99, v43
  v_cvt_pk_bf16_f32 v60, v90, v91
  v_cvt_pk_bf16_f32 v61, v92, v93
  v_cvt_pk_bf16_f32 v62, v94, v95
  v_cvt_pk_bf16_f32 v63, v96, v97
  v_cvt_pk_bf16_f32 v64, v98, v99
  ds_write_b32 v38, v60 offset:0
  ds_write_b32 v38, v61 offset:256
  ds_write_b32 v38, v62 offset:512
  ds_write_b32 v38, v63 offset:768
  s_mov_b32 exec_hi, 0
  ds_write_b32 v38, v64 offset:1024
  s_mov_b64 exec, -1
  s_waitcnt lgkmcnt(0)
  s_mov_b64 exec, 1
  ds_add_u32 v1, v2 offset:36
  s_mov_b64 exec, -1
  v_lshrrev_b32 v12, 4, v0
  v_bfe_u32 v13, v0, 3, 1
  s_movk_i32 s53, 1160
  v_mul_lo_u32 v14, v13, s53
  v_lshl_add_u32 v14, v12, 1, v14
  v_add_u32 v14, 157696, v14
  v_lshlrev_b32 v15, 4, v0
Lw1_34:
  s_add_u32 s18, s18, 1
  s_cmp_gt_u32 s18, 4194304
  s_cbranch_scc1 Lend
  ds_read_b32 v3, v1 offset:36
  s_waitcnt lgkmcnt(0)
  v_readfirstlane_b32 s53, v3
  s_cmp_ge_i32 s53, 2
  s_cbranch_scc0 Lw1_34
  s_mul_i32 s53, s37, 144
  v_add_u32 v11, s53, v14
  v_add_u32 v10, 139264, v15
  v_mov_b32 v40, 0
  v_mov_b32 v41, 0
  v_mov_b32 v42, 0
  v_mov_b32 v43, 0
  s_mov_b32 s55, 9
  s_waitcnt lgkmcnt(0)
Lqp_35:
Lwf_36:
  s_cmp_ge_i32 s52, s55
  s_cbranch_scc1 Lwfd_37
  s_add_u32 s18, s18, 1
  s_cmp_gt_u32 s18, 4194304
  s_cbranch_scc1 Lend
  ds_read_b32 v3, v1 offset:0
  s_waitcnt lgkmcnt(0)
  v_readfirstlane_b32 s52, v3
  s_branch Lwf_36
Lwfd_37:
  ds_read_u16 v72, v11 offset:0
  ds_read_b128 v[48:51], v10 offset:0
  ds_read_u16 v73, v11 offset:8
  ds_read_b128 v[52:55], v10 offset:1024
  ds_read_u16 v74, v11 offset:16
  ds_read_b128 v[56:59], v10 offset:2048
  ds_read_u16 v75, v11 offset:24
  ds_read_b128 v[60:63], v10 offset:3072
  ds_read_u16 v76, v11 offset:32
  ds_read_b128 v[64:67], v10 offset:4096
  ds_read_u16 v77, v11 offset:40
  ds_read_b128 v[68:71], v10 offset:5120
  s_waitcnt lgkmcnt(10)
  v_lshl_or_b32 v72, v72, 16, v72
  v_and_b32 v80, v72, v4
  v_and_b32 v81, v72, v5
  v_and_b32 v82, v72, v6
  v_and_b32 v83, v72, v7
  s_nop 1
  v_mfma_f32_16x16x32_bf16 v[40:43], v[48:51], v[80:83], v[40:43]
  s_waitcnt lgkmcnt(8)
  v_lshl_or_b32 v73, v73, 16, v73
  v_and_b32 v84, v73, v4
  v_and_b32 v85, v73, v5
  v_and_b32 v86, v73, v6
  v_and_b32 v87, v73, v7
  s_nop 1
  v_mfma_f32_16x16x32_bf16 v[40:43], v[52:55], v[84:87], v[40:43]
  s_waitcnt lgkmcnt(6)
  v_lshl_or_b32 v74, v74, 16, v74
  v_and_b32 v80, v74, v4
  v_and_b32 v81, v74, v5
  v_and_b32 v82, v74, v6
  v_and_b32 v83, v74, v7
  s_nop 1
  v_mfma_f32_16x16x32_bf16 v[40:43], v[56:59], v[80:83], v[40:43]
  s_waitcnt lgkmcnt(4)
  v_lshl_or_b32 v75, v75, 16, v75
  v_and_b32 v84, v75, v4
  v_and_b32 v85, v75, v5
  v_and_b32 v86, v75, v6
  v_and_b32 v87, v75, v7
  s_nop 1
  v_mfma_f32_16x16x32_bf16 v[40:43], v[60:63], v[84:87], v[40:43]
  s_waitcnt lgkmcnt(2)
  v_lshl_or_b32 v76, v76, 16, v76
  v_and_b32 v80, v76, v4
  v_and_b32 v81, v76, v5
  v_and_b32 v82, v76, v6
  v_and_b32 v83, v76, v7
  s_nop 1
  v_mfma_f32_16x16x32_bf16 v[40:43], v[64:67], v[80:83], v[40:43]
  s_waitcnt lgkmcnt(0)
  v_lshl_or_b32 v77, v77, 16, v77
  v_and_b32 v84, v77, v4
  v_and_b32 v85, v77, v5
  v_and_b32 v86, v77, v6
  v_and_b32 v87, v77, v7
  s_nop 1
  v_mfma_f32_16x16x32_bf16 v[40:43], v[68:71], v[84:87], v[40:43]
  v_add_u32 v11, 48, v11
  v_add_u32 v10, 6144, v10
  s_add_u32 s55, s55, 6
  s_cmp_le_u32 s55, 21
  s_cbranch_scc1 Lqp_35
  s_waitcnt lgkmcnt(0)
  s_mov_b64 exec, 1
  ds_add_u32 v1, v2 offset:4
  s_mov_b64 exec, -1
  s_mov_b32 s56, 0xffffff00
  v_lshlrev_b32 v16, 12, v13
  v_lshl_add_u32 v16, v12, 7, v16
  v_and_b32 v3, 7, v0
  v_lshl_add_u32 v16, v3, 4, v16
  s_lshl_b32 s53, s34, 1
  s_add_u32 s53, s53, s36
  s_lshl_b32 s53, s53, 13
  s_lshl_b32 s54, s37, 9
  s_add_u32 s53, s53, s54
  s_add_u32 s53, s53, 4096
  s_nop 2
  v_add_u32 v40, 0x80, v40
  v_add_u32 v41, 0x80, v41
  v_add_u32 v42, 0x80, v42
  v_add_u32 v43, 0x80, v43
  v_and_or_b32 v40, v40, s56, v9
  v_and_or_b32 v41, v41, s56, v9
  v_and_or_b32 v42, v42, s56, v9
  v_and_or_b32 v43, v43, s56, v9
  buffer_store_dwordx4 v[40:43], v16, s[44:47], s53 offen sc1
  s_waitcnt vmcnt(0)
  s_lshl_b32 s53, s34, 14
  s_lshl_b32 s54, s36, 12
  s_add_u32 s53, s53, s54
  s_add_u32 s53, s53, 4096
  s_add_u32 s54, s53, 8192
  s_mov_b32 s55, 0
Lg1_38:
  s_add_u32 s55, s55, 1
  s_cmp_gt_u32 s55, 32768
  s_cbranch_scc1 Lg1d_39
  buffer_load_dwordx4 v[48:51], v15, s[44:47], s53 offen offset:0 sc1
  buffer_load_dwordx4 v[52:55], v15, s[44:47], s53 offen offset:1024 sc1
  buffer_load_dwordx4 v[56:59], v15, s[44:47], s53 offen offset:2048 sc1
  buffer_load_dwordx4 v[60:63], v15, s[44:47], s53 offen offset:3072 sc1
  buffer_load_dwordx4 v[64:67], v15, s[44:47], s54 offen offset:0 sc1
  buffer_load_dwordx4 v[68:71], v15, s[44:47], s54 offen offset:1024 sc1
  buffer_load_dwordx4 v[72:75], v15, s[44:47], s54 offen offset:2048 sc1
  buffer_load_dwordx4 v[76:79], v15, s[44:47], s54 offen offset:3072 sc1
  s_waitcnt vmcnt(0)
  v_bitop3_b32 v81, v48, v49, v9 bitop3:0x7e
  v_bitop3_b32 v80, v50, v51, v9 bitop3:0x7e
  v_or_b32 v80, v80, v81
  v_bitop3_b32 v81, v52, v53, v9 bitop3:0x7e
  v_bitop3_b32 v82, v54, v55, v9 bitop3:0x7e
  v_or3_b32 v80, v80, v81, v82
  v_bitop3_b32 v81, v56, v57, v9 bitop3:0x7e
  v_bitop3_b32 v82, v58, v59, v9 bitop3:0x7e
  v_or3_b32 v80, v80, v81, v82
  v_bitop3_b32 v81, v60, v61, v9 bitop3:0x7e
  v_bitop3_b32 v82, v62, v63, v9 bitop3:0x7e
  v_or3_b32 v80, v80, v81, v82
  v_bitop3_b32 v81, v64, v65, v9 bitop3:0x7e
  v_bitop3_b32 v82, v66, v67, v9 bitop3:0x7e
  v_or3_b32 v80, v80, v81, v82
  v_bitop3_b32 v81, v68, v69, v9 bitop3:0x7e
  v_bitop3_b32 v82, v70, v71, v9 bitop3:0x7e
  v_or3_b32 v80, v80, v81, v82
  v_bitop3_b32 v81, v72, v73, v9 bitop3:0x7e
  v_bitop3_b32 v82, v74, v75, v9 bitop3:0x7e
  v_or3_b32 v80, v80, v81, v82
  v_bitop3_b32 v81, v76, v77, v9 bitop3:0x7e
  v_bitop3_b32 v82, v78, v79, v9 bitop3:0x7e
  v_or3_b32 v80, v80, v81, v82
  v_and_b32 v80, 0xff, v80
  v_cmp_ne_u32 vcc, 0, v80
  s_nop 1
  s_cbranch_vccnz Lg1_38
Lg1d_39:
  v_and_b32 v48, s56, v48
  v_and_b32 v49, s56, v49
  v_and_b32 v50, s56, v50
  v_and_b32 v51, s56, v51
  v_and_b32 v52, s56, v52
  v_and_b32 v53, s56, v53
  v_and_b32 v54, s56, v54
  v_and_b32 v55, s56, v55
  v_and_b32 v56, s56, v56
  v_and_b32 v57, s56, v57
  v_and_b32 v58, s56, v58
  v_and_b32 v59, s56, v59
  v_and_b32 v60, s56, v60
  v_and_b32 v61, s56, v61
  v_and_b32 v62, s56, v62
  v_and_b32 v63, s56, v63
  v_and_b32 v64, s56, v64
  v_and_b32 v65, s56, v65
  v_and_b32 v66, s56, v66
  v_and_b32 v67, s56, v67
  v_and_b32 v68, s56, v68
  v_and_b32 v69, s56, v69
  v_and_b32 v70, s56, v70
  v_and_b32 v71, s56, v71
  v_and_b32 v72, s56, v72
  v_and_b32 v73, s56, v73
  v_and_b32 v74, s56, v74
  v_and_b32 v75, s56, v75
  v_and_b32 v76, s56, v76
  v_and_b32 v77, s56, v77
  v_and_b32 v78, s56, v78
  v_and_b32 v79, s56, v79
  v_add_f32 v48, v48, v52
  v_add_f32 v49, v49, v53
  v_add_f32 v50, v50, v54
  v_add_f32 v51, v51, v55
  v_add_f32 v48, v48, v56
  v_add_f32 v49, v49, v57
  v_add_f32 v50, v50, v58
  v_add_f32 v51, v51, v59
  v_add_f32 v48, v48, v60
  v_add_f32 v49, v49, v61
  v_add_f32 v50, v50, v62
  v_add_f32 v51, v51, v63
  v_add_f32 v64, v64, v68
  v_add_f32 v65, v65, v69
  v_add_f32 v66, v66, v70
  v_add_f32 v67, v67, v71
  v_add_f32 v64, v64, v72
  v_add_f32 v65, v65, v73
  v_add_f32 v66, v66, v74
  v_add_f32 v67, v67, v75
  v_add_f32 v64, v64, v76
  v_add_f32 v65, v65, v77
  v_add_f32 v66, v66, v78
  v_add_f32 v67, v67, v79
  s_nop 1
  v_permlane32_swap_b32 v48, v64
  v_permlane32_swap_b32 v49, v65
  v_permlane32_swap_b32 v50, v66
  v_permlane32_swap_b32 v51, v67
  s_nop 1
  v_add_f32 v48, v48, v64
  v_add_f32 v49, v49, v65
  v_add_f32 v50, v50, v66
  v_add_f32 v51, v51, v67
  v_cvt_pk_bf16_f32 v48, v48, v48
  v_cvt_pk_bf16_f32 v49, v49, v49
  v_cvt_pk_bf16_f32 v50, v50, v50
  v_cvt_pk_bf16_f32 v51, v51, v51
  v_lshrrev_b32 v3, 5, v0
  s_movk_i32 s53, 272
  v_mul_lo_u32 v3, v3, s53
  v_bfe_u32 v80, v0, 3, 2
  v_lshl_add_u32 v3, v80, 6, v3
  v_and_b32 v80, 7, v0
  v_lshl_add_u32 v3, v80, 1, v3
  v_add_u32 v3, 160016, v3
  ds_write_b16 v3, v48 offset:0
  ds_write_b16 v3, v49 offset:16
  ds_write_b16 v3, v50 offset:32
  ds_write_b16 v3, v51 offset:48
  s_waitcnt lgkmcnt(0)
  s_mov_b64 exec, 1
  ds_add_u32 v1, v2 offset:8
  s_mov_b64 exec, -1
  s_mul_i32 s60, s40, -120832
  s_add_u32 s60, s60, 139264
  s_mul_i32 s61, s40, 36864
  s_add_u32 s61, s61, 0
  s_mul_i32 s62, s40, -28
  s_add_u32 s62, s62, 175
  s_mov_b32 s63, s38
  s_mov_b32 s64, s39
  s_mov_b32 s65, s2
  s_mov_b32 s66, 1
  s_mul_i32 s67, s40, 51200
  s_add_u32 s67, s67, 36864
  s_mul_i32 s68, s40, -10
  s_add_u32 s68, s68, 211
  s_mov_b32 s69, 161840
Lmphase:
  s_mov_b32 s56, 0xfffff000
  s_mul_i32 s53, s64, 144
  v_add_u32 v11, s53, v14
  ds_read_u16 v48, v11 offset:0
  ds_read_u16 v49, v11 offset:8
  ds_read_u16 v50, v11 offset:16
  ds_read_u16 v51, v11 offset:24
  ds_read_u16 v52, v11 offset:32
  ds_read_u16 v53, v11 offset:40
  ds_read_u16 v54, v11 offset:48
  ds_read_u16 v55, v11 offset:56
  ds_read_u16 v56, v11 offset:64
  s_waitcnt lgkmcnt(8)
  v_lshl_or_b32 v48, v48, 16, v48
  v_and_b32 v88, v48, v4
  v_and_b32 v89, v48, v5
  v_and_b32 v90, v48, v6
  v_and_b32 v91, v48, v7
  s_waitcnt lgkmcnt(7)
  v_lshl_or_b32 v49, v49, 16, v49
  v_and_b32 v92, v49, v4
  v_and_b32 v93, v49, v5
  v_and_b32 v94, v49, v6
  v_and_b32 v95, v49, v7
  s_waitcnt lgkmcnt(6)
  v_lshl_or_b32 v50, v50, 16, v50
  v_and_b32 v96, v50, v4
  v_and_b32 v97, v50, v5
  v_and_b32 v98, v50, v6
  v_and_b32 v99, v50, v7
  s_waitcnt lgkmcnt(5)
  v_lshl_or_b32 v51, v51, 16, v51
  v_and_b32 v100, v51, v4
  v_and_b32 v101, v51, v5
  v_and_b32 v102, v51, v6
  v_and_b32 v103, v51, v7
  s_waitcnt lgkmcnt(4)
  v_lshl_or_b32 v52, v52, 16, v52
  v_and_b32 v104, v52, v4
  v_and_b32 v105, v52, v5
  v_and_b32 v106, v52, v6
  v_and_b32 v107, v52, v7
  s_waitcnt lgkmcnt(3)
  v_lshl_or_b32 v53, v53, 16, v53
  v_and_b32 v108, v53, v4
  v_and_b32 v109, v53, v5
  v_and_b32 v110, v53, v6
  v_and_b32 v111, v53, v7
  s_waitcnt lgkmcnt(2)
  v_lshl_or_b32 v54, v54, 16, v54
  v_and_b32 v112, v54, v4
  v_and_b32 v113, v54, v5
  v_and_b32 v114, v54, v6
  v_and_b32 v115, v54, v7
  s_waitcnt lgkmcnt(1)
  v_lshl_or_b32 v55, v55, 16, v55
  v_and_b32 v116, v55, v4
  v_and_b32 v117, v55, v5
  v_and_b32 v118, v55, v6
  v_and_b32 v119, v55, v7
  s_waitcnt lgkmcnt(0)
  v_lshl_or_b32 v56, v56, 16, v56
  v_and_b32 v120, v56, v4
  v_and_b32 v121, v56, v5
  v_and_b32 v122, v56, v6
  v_and_b32 v123, v56, v7
  ds_read_u16 v48, v11 offset:72
  ds_read_u16 v49, v11 offset:80
  ds_read_u16 v50, v11 offset:88
  ds_read_u16 v51, v11 offset:96
  ds_read_u16 v52, v11 offset:104
  ds_read_u16 v53, v11 offset:112
  ds_read_u16 v54, v11 offset:120
  ds_read_u16 v55, v11 offset:128
  ds_read_u16 v56, v11 offset:136
  s_waitcnt lgkmcnt(8)
  v_lshl_or_b32 v48, v48, 16, v48
  v_and_b32 v124, v48, v4
  v_and_b32 v125, v48, v5
  v_and_b32 v126, v48, v6
  v_and_b32 v127, v48, v7
  s_waitcnt lgkmcnt(7)
  v_lshl_or_b32 v49, v49, 16, v49
  v_and_b32 v128, v49, v4
  v_and_b32 v129, v49, v5
  v_and_b32 v130, v49, v6
  v_and_b32 v131, v49, v7
  s_waitcnt lgkmcnt(6)
  v_lshl_or_b32 v50, v50, 16, v50
  v_and_b32 v132, v50, v4
  v_and_b32 v133, v50, v5
  v_and_b32 v134, v50, v6
  v_and_b32 v135, v50, v7
  s_waitcnt lgkmcnt(5)
  v_lshl_or_b32 v51, v51, 16, v51
  v_and_b32 v136, v51, v4
  v_and_b32 v137, v51, v5
  v_and_b32 v138, v51, v6
  v_and_b32 v139, v51, v7
  s_waitcnt lgkmcnt(4)
  v_lshl_or_b32 v52, v52, 16, v52
  v_and_b32 v140, v52, v4
  v_and_b32 v141, v52, v5
  v_and_b32 v142, v52, v6
  v_and_b32 v143, v52, v7
  s_waitcnt lgkmcnt(3)
  v_lshl_or_b32 v53, v53, 16, v53
  v_and_b32 v144, v53, v4
  v_and_b32 v145, v53, v5
  v_and_b32 v146, v53, v6
  v_and_b32 v147, v53, v7
  s_waitcnt lgkmcnt(2)
  v_lshl_or_b32 v54, v54, 16, v54
  v_and_b32 v148, v54, v4
  v_and_b32 v149, v54, v5
  v_and_b32 v150, v54, v6
  v_and_b32 v151, v54, v7
  s_waitcnt lgkmcnt(1)
  v_lshl_or_b32 v55, v55, 16, v55
  v_and_b32 v152, v55, v4
  v_and_b32 v153, v55, v5
  v_and_b32 v154, v55, v6
  v_and_b32 v155, v55, v7
  s_waitcnt lgkmcnt(0)
  v_lshl_or_b32 v56, v56, 16, v56
  v_and_b32 v156, v56, v4
  v_and_b32 v157, v56, v5
  v_and_b32 v158, v56, v6
  v_and_b32 v159, v56, v7
  v_lshlrev_b32 v16, 12, v12
  v_and_b32 v3, 15, v0
  v_lshl_add_u32 v16, v3, 4, v16
  s_lshl_b32 s71, s63, 14
  s_lshl_b32 s54, s64, 8
  s_add_u32 s71, s71, s54
  s_add_u32 s71, s71, 561152
  s_mov_b32 s70, 0
  v_add_u32 v10, s60, v15
  s_sub_u32 s54, s62, 18
Lpass_40:
  v_mov_b32 v44, 0
  v_mov_b32 v45, 0
  v_mov_b32 v46, 0
  v_mov_b32 v47, 0
  s_add_u32 s55, s54, 3
Lwf_42:
  s_cmp_ge_i32 s52, s55
  s_cbranch_scc1 Lwfd_43
  s_add_u32 s18, s18, 1
  s_cmp_gt_u32 s18, 4194304
  s_cbranch_scc1 Lend
  ds_read_b32 v3, v1 offset:0
  s_waitcnt lgkmcnt(0)
  v_readfirstlane_b32 s52, v3
  s_branch Lwf_42
Lwfd_43:
  ds_read_b128 v[48:51], v10 offset:0
  ds_read_b128 v[52:55], v10 offset:1024
  ds_read_b128 v[56:59], v10 offset:2048
  s_waitcnt lgkmcnt(2)
  v_mfma_f32_16x16x32_bf16 v[44:47], v[48:51], v[88:91], v[44:47]
  s_waitcnt lgkmcnt(1)
  v_mfma_f32_16x16x32_bf16 v[44:47], v[52:55], v[92:95], v[44:47]
  s_waitcnt lgkmcnt(0)
  v_mfma_f32_16x16x32_bf16 v[44:47], v[56:59], v[96:99], v[44:47]
  s_add_u32 s55, s54, 6
Lwf_44:
  s_cmp_ge_i32 s52, s55
  s_cbranch_scc1 Lwfd_45
  s_add_u32 s18, s18, 1
  s_cmp_gt_u32 s18, 4194304
  s_cbranch_scc1 Lend
  ds_read_b32 v3, v1 offset:0
  s_waitcnt lgkmcnt(0)
  v_readfirstlane_b32 s52, v3
  s_branch Lwf_44
Lwfd_45:
  ds_read_b128 v[60:63], v10 offset:3072
  ds_read_b128 v[64:67], v10 offset:4096
  ds_read_b128 v[68:71], v10 offset:5120
  s_waitcnt lgkmcnt(2)
  v_mfma_f32_16x16x32_bf16 v[44:47], v[60:63], v[100:103], v[44:47]
  s_waitcnt lgkmcnt(1)
  v_mfma_f32_16x16x32_bf16 v[44:47], v[64:67], v[104:107], v[44:47]
  s_waitcnt lgkmcnt(0)
  v_mfma_f32_16x16x32_bf16 v[44:47], v[68:71], v[108:111], v[44:47]
  s_add_u32 s55, s54, 9
Lwf_46:
  s_cmp_ge_i32 s52, s55
  s_cbranch_scc1 Lwfd_47
  s_add_u32 s18, s18, 1
  s_cmp_gt_u32 s18, 4194304
  s_cbranch_scc1 Lend
  ds_read_b32 v3, v1 offset:0
  s_waitcnt lgkmcnt(0)
  v_readfirstlane_b32 s52, v3
  s_branch Lwf_46
Lwfd_47:
  ds_read_b128 v[48:51], v10 offset:6144
  ds_read_b128 v[52:55], v10 offset:7168
  ds_read_b128 v[56:59], v10 offset:8192
  s_waitcnt lgkmcnt(2)
  v_mfma_f32_16x16x32_bf16 v[44:47], v[48:51], v[112:115], v[44:47]
  s_waitcnt lgkmcnt(1)
  v_mfma_f32_16x16x32_bf16 v[44:47], v[52:55], v[116:119], v[44:47]
  s_waitcnt lgkmcnt(0)
  v_mfma_f32_16x16x32_bf16 v[44:47], v[56:59], v[120:123], v[44:47]
  s_add_u32 s55, s54, 12
Lwf_48:
  s_cmp_ge_i32 s52, s55
  s_cbranch_scc1 Lwfd_49
  s_add_u32 s18, s18, 1
  s_cmp_gt_u32 s18, 4194304
  s_cbranch_scc1 Lend
  ds_read_b32 v3, v1 offset:0
  s_waitcnt lgkmcnt(0)
  v_readfirstlane_b32 s52, v3
  s_branch Lwf_48
Lwfd_49:
  ds_read_b128 v[60:63], v10 offset:9216
  ds_read_b128 v[64:67], v10 offset:10240
  ds_read_b128 v[68:71], v10 offset:11264
  s_waitcnt lgkmcnt(2)
  v_mfma_f32_16x16x32_bf16 v[44:47], v[60:63], v[124:127], v[44:47]
  s_waitcnt lgkmcnt(1)
  v_mfma_f32_16x16x32_bf16 v[44:47], v[64:67], v[128:131], v[44:47]
  s_waitcnt lgkmcnt(0)
  v_mfma_f32_16x16x32_bf16 v[44:47], v[68:71], v[132:135], v[44:47]
  s_add_u32 s55, s54, 15
Lwf_50:
  s_cmp_ge_i32 s52, s55
  s_cbranch_scc1 Lwfd_51
  s_add_u32 s18, s18, 1
  s_cmp_gt_u32 s18, 4194304
  s_cbranch_scc1 Lend
  ds_read_b32 v3, v1 offset:0
  s_waitcnt lgkmcnt(0)
  v_readfirstlane_b32 s52, v3
  s_branch Lwf_50
Lwfd_51:
  ds_read_b128 v[48:51], v10 offset:12288
  ds_read_b128 v[52:55], v10 offset:13312
  ds_read_b128 v[56:59], v10 offset:14336
  s_waitcnt lgkmcnt(2)
  v_mfma_f32_16x16x32_bf16 v[44:47], v[48:51], v[136:139], v[44:47]
  s_waitcnt lgkmcnt(1)
  v_mfma_f32_16x16x32_bf16 v[44:47], v[52:55], v[140:143], v[44:47]
  s_waitcnt lgkmcnt(0)
  v_mfma_f32_16x16x32_bf16 v[44:47], v[56:59], v[144:147], v[44:47]
  s_add_u32 s55, s54, 18
Lwf_52:
  s_cmp_ge_i32 s52, s55
  s_cbranch_scc1 Lwfd_53
  s_add_u32 s18, s18, 1
  s_cmp_gt_u32 s18, 4194304
  s_cbranch_scc1 Lend
  ds_read_b32 v3, v1 offset:0
  s_waitcnt lgkmcnt(0)
  v_readfirstlane_b32 s52, v3
  s_branch Lwf_52
Lwfd_53:
  ds_read_b128 v[60:63], v10 offset:15360
  ds_read_b128 v[64:67], v10 offset:16384
  ds_read_b128 v[68:71], v10 offset:17408
  s_waitcnt lgkmcnt(2)
  v_mfma_f32_16x16x32_bf16 v[44:47], v[60:63], v[148:151], v[44:47]
  s_waitcnt lgkmcnt(1)
  v_mfma_f32_16x16x32_bf16 v[44:47], v[64:67], v[152:155], v[44:47]
  s_waitcnt lgkmcnt(0)
  v_mfma_f32_16x16x32_bf16 v[44:47], v[68:71], v[156:159], v[44:47]
  s_cmp_lg_u32 s70, 0
  s_cbranch_scc1 Lpassd_41
  s_mov_b32 s70, 1
  v_add_u32 v10, s61, v15
  s_mov_b32 s54, s62
  s_nop 4
  v_mov_b32 v40, v44
  v_mov_b32 v41, v45
  v_mov_b32 v42, v46
  v_mov_b32 v43, v47
  s_nop 2
  s_branch Lpass_40
Lpassd_41:
  s_mov_b32 s53, s71
  s_nop 5
  v_and_or_b32 v48, v40, s56, v8
  v_and_or_b32 v49, v41, s56, v8
  v_and_or_b32 v50, v44, s56, v8
  v_and_or_b32 v51, v45, s56, v8
  v_and_or_b32 v52, v42, s56, v8
  v_and_or_b32 v53, v43, s56, v8
  v_and_or_b32 v54, v46, s56, v8
  v_and_or_b32 v55, v47, s56, v8
  buffer_store_dwordx4 v[48:51], v16, s[44:47], s53 offen sc1
  buffer_store_dwordx4 v[52:55], v16, s[44:47], s53 offen offset:2048 sc1
  v_lshrrev_b32 v20, 3, v0
  s_mov_b32 s53, 36864
  v_mul_lo_u32 v20, v20, s53
  v_and_b32 v3, 7, v0
  v_lshl_add_u32 v20, v3, 4, v20
  v_add_u32 v21, 126976, v15
  v_and_b32 v24, 7, v0
  v_lshl_add_u32 v24, v12, 4, v24
  v_lshlrev_b32 v24, 4, v24
  v_lshlrev_b32 v25, 6, v13
  v_and_b32 v3, 7, v0
  v_lshl_add_u32 v26, v3, 2, v25
  v_add_u32 v26, s69, v26
  v_lshl_add_u32 v25, v12, 4, v25
  v_add_u32 v25, s69, v25
  s_waitcnt vmcnt(0)
  s_lshl_b32 s53, s63, 3
  s_add_u32 s53, s53, s64
  s_lshl_b32 s53, s53, 11
  s_add_u32 s53, s53, 561152
  s_mov_b32 s20, 0
  buffer_load_dwordx4 v[48:51], v15, s[44:47], s53 offen sc1
  buffer_load_dwordx4 v[52:55], v15, s[44:47], s53 offen offset:1024 sc1
  v_add_u32 v22, s67, v15
  s_add_u32 s54, s67, 16384
  v_add_u32 v23, s54, v24
  s_cmp_lg_u32 s66, 0
  s_cbranch_scc1 Lskr_59
  s_add_u32 s55, s68, 4
Lwf_60:
  s_cmp_ge_i32 s52, s55
  s_cbranch_scc1 Lwfd_61
  s_add_u32 s18, s18, 1
  s_cmp_gt_u32 s18, 4194304
  s_cbranch_scc1 Lend
  ds_read_b32 v3, v1 offset:0
  s_waitcnt lgkmcnt(0)
  v_readfirstlane_b32 s52, v3
  s_branch Lwf_60
Lwfd_61:
  ds_read_b128 v[88:91], v22 offset:0
  ds_read_b128 v[92:95], v22 offset:1024
  ds_read_b128 v[96:99], v22 offset:2048
  ds_read_b128 v[100:103], v22 offset:3072
  s_add_u32 s55, s68, 8
Lwf_62:
  s_cmp_ge_i32 s52, s55
  s_cbranch_scc1 Lwfd_63
  s_add_u32 s18, s18, 1
  s_cmp_gt_u32 s18, 4194304
  s_cbranch_scc1 Lend
  ds_read_b32 v3, v1 offset:0
  s_waitcnt lgkmcnt(0)
  v_readfirstlane_b32 s52, v3
  s_branch Lwf_62
Lwfd_63:
  ds_read_b128 v[104:107], v22 offset:4096
  ds_read_b128 v[108:111], v22 offset:5120
  ds_read_b128 v[112:115], v22 offset:6144
  ds_read_b128 v[116:119], v22 offset:7168
  s_add_u32 s55, s68, 12
Lwf_64:
  s_cmp_ge_i32 s52, s55
  s_cbranch_scc1 Lwfd_65
  s_add_u32 s18, s18, 1
  s_cmp_gt_u32 s18, 4194304
  s_cbranch_scc1 Lend
  ds_read_b32 v3, v1 offset:0
  s_waitcnt lgkmcnt(0)
  v_readfirstlane_b32 s52, v3
  s_branch Lwf_64
Lwfd_65:
  ds_read_b128 v[120:123], v22 offset:8192
  ds_read_b128 v[124:127], v22 offset:9216
  ds_read_b128 v[128:131], v22 offset:10240
  ds_read_b128 v[132:135], v22 offset:11264
  s_add_u32 s55, s68, 16
Lwf_66:
  s_cmp_ge_i32 s52, s55
  s_cbranch_scc1 Lwfd_67
  s_add_u32 s18, s18, 1
  s_cmp_gt_u32 s18, 4194304
  s_cbranch_scc1 Lend
  ds_read_b32 v3, v1 offset:0
  s_waitcnt lgkmcnt(0)
  v_readfirstlane_b32 s52, v3
  s_branch Lwf_66
Lwfd_67:
  s_waitcnt lgkmcnt(3)
  ds_read_b128 v[136:139], v22 offset:12288
  ds_read_b128 v[140:143], v22 offset:13312
  ds_read_b128 v[144:147], v22 offset:14336
  ds_read_b128 v[148:151], v22 offset:15360
  s_add_u32 s55, s68, 18
Lwf_68:
  s_cmp_ge_i32 s52, s55
  s_cbranch_scc1 Lwfd_69
  s_add_u32 s18, s18, 1
  s_cmp_gt_u32 s18, 4194304
  s_cbranch_scc1 Lend
  ds_read_b32 v3, v1 offset:0
  s_waitcnt lgkmcnt(0)
  v_readfirstlane_b32 s52, v3
  s_branch Lwf_68
Lwfd_69:
  ds_read_b128 v[152:155], v23 offset:0
  ds_read_b128 v[156:159], v23 offset:128
  ds_read_b128 v[160:163], v23 offset:1024
  ds_read_b128 v[164:167], v23 offset:1152
Lskr_59:
  s_branch Lgmp_58
Lgm_56:
  s_add_u32 s20, s20, 1
  s_cmp_gt_u32 s20, 32768
  s_cbranch_scc1 Lgmd_57
  buffer_load_dwordx4 v[48:51], v15, s[44:47], s53 offen sc1
  buffer_load_dwordx4 v[52:55], v15, s[44:47], s53 offen offset:1024 sc1
Lgmp_58:
  s_waitcnt vmcnt(0)
  v_bitop3_b32 v81, v48, v49, v8 bitop3:0x7e
  v_bitop3_b32 v80, v50, v51, v8 bitop3:0x7e
  v_or_b32 v80, v80, v81
  v_bitop3_b32 v81, v52, v53, v8 bitop3:0x7e
  v_bitop3_b32 v82, v54, v55, v8 bitop3:0x7e
  v_or3_b32 v80, v80, v81, v82
  v_and_b32 v80, 0xfff, v80
  v_cmp_ne_u32 vcc, 0, v80
  s_nop 1
  s_cbranch_vccnz Lgm_56
Lgmd_57:
  v_and_b32 v48, s56, v48
  v_and_b32 v49, s56, v49
  v_and_b32 v50, s56, v50
  v_and_b32 v51, s56, v51
  v_and_b32 v52, s56, v52
  v_and_b32 v53, s56, v53
  v_and_b32 v54, s56, v54
  v_and_b32 v55, s56, v55
  v_add_f32 v48, v48, v52
  v_add_f32 v49, v49, v53
  v_add_f32 v50, v50, v54
  v_add_f32 v51, v51, v55
  v_mov_b32 v52, v48
  v_mov_b32 v53, v49
  v_mov_b32 v54, v50
  v_mov_b32 v55, v51
  s_nop 1
  v_permlane16_swap_b32 v48, v52
  v_permlane16_swap_b32 v49, v53
  v_permlane16_swap_b32 v50, v54
  v_permlane16_swap_b32 v51, v55
  s_nop 1
  v_add_f32 v48, v48, v52
  v_add_f32 v49, v49, v53
  v_add_f32 v50, v50, v54
  v_add_f32 v51, v51, v55
  v_mov_b32 v52, v48
  v_mov_b32 v53, v49
  v_mov_b32 v54, v50
  v_mov_b32 v55, v51
  s_nop 1
  v_permlane32_swap_b32 v48, v52
  v_permlane32_swap_b32 v49, v53
  v_permlane32_swap_b32 v50, v54
  v_permlane32_swap_b32 v51, v55
  s_nop 1
  v_add_f32 v48, v48, v52
  v_add_f32 v49, v49, v53
  v_add_f32 v50, v50, v54
  v_add_f32 v51, v51, v55
Lhsum_55:
  v_cvt_pk_bf16_f32 v52, v48, v49
  v_cvt_pk_bf16_f32 v53, v50, v51
  v_lshlrev_b32 v48, 16, v52
  v_and_b32 v49, 0xffff0000, v52
  v_lshlrev_b32 v50, 16, v53
  v_and_b32 v51, 0xffff0000, v53
  v_max_f32 v48, 0, v48
  v_max_f32 v49, 0, v49
  v_mul_f32 v48, v48, v50
  v_mul_f32 v49, v49, v51
  v_cvt_pk_bf16_f32 v48, v48, v48
  v_cvt_pk_bf16_f32 v49, v49, v49
  s_mov_b64 exec, 0xffff
  ds_write_b32 v26, v48
  ds_write_b32 v26, v49 offset:32
  s_mov_b64 exec, -1
  s_cmp_eq_u32 s66, 0
  s_cbranch_scc1 Lnm_70
  s_waitcnt lgkmcnt(0)
  s_mov_b64 exec, 1
  ds_add_u32 v1, v2 offset:24
  s_mov_b64 exec, -1
  s_endpgm
Lnm_70:
  ds_read_b128 v[52:55], v25
  s_cmp_eq_u32 s66, 0
  s_cbranch_scc1 Lcz_71
Lw1_73:
  s_add_u32 s18, s18, 1
  s_cmp_gt_u32 s18, 4194304
  s_cbranch_scc1 Lend
  ds_read_b32 v3, v1 offset:24
  s_waitcnt lgkmcnt(0)
  v_readfirstlane_b32 s53, v3
  s_cmp_ge_i32 s53, 1
  s_cbranch_scc0 Lw1_73
  ds_read_b128 v[56:59], v21 offset:0
  ds_read_b128 v[60:63], v21 offset:1024
  ds_read_b128 v[64:67], v21 offset:2048
  ds_read_b128 v[68:71], v21 offset:3072
  ds_read_b128 v[72:75], v21 offset:4096
  s_branch Lcc_72
Lcz_71:
  v_mov_b32 v56, 0
  v_mov_b32 v57, 0
  v_mov_b32 v58, 0
  v_mov_b32 v59, 0
  v_mov_b32 v60, 0
  v_mov_b32 v61, 0
  v_mov_b32 v62, 0
  v_mov_b32 v63, 0
  v_mov_b32 v64, 0
  v_mov_b32 v65, 0
  v_mov_b32 v66, 0
  v_mov_b32 v67, 0
  v_mov_b32 v68, 0
  v_mov_b32 v69, 0
  v_mov_b32 v70, 0
  v_mov_b32 v71, 0
  v_mov_b32 v72, 0
  v_mov_b32 v73, 0
  v_mov_b32 v74, 0
  v_mov_b32 v75, 0
Lcc_72:
  s_waitcnt lgkmcnt(0)
  v_and_b32 v28, v52, v4
  v_and_b32 v29, v52, v5
  v_and_b32 v30, v52, v6
  v_and_b32 v31, v52, v7
  v_and_b32 v32, v53, v4
  v_and_b32 v33, v53, v5
  v_and_b32 v34, v53, v6
  v_and_b32 v35, v53, v7
  v_and_b32 v36, v54, v4
  v_and_b32 v37, v54, v5
  v_and_b32 v38, v54, v6
  v_and_b32 v39, v54, v7
  v_and_b32 v40, v55, v4
  v_and_b32 v41, v55, v5
  v_and_b32 v42, v55, v6
  v_and_b32 v43, v55, v7
  s_lshl_b32 s54, s65, 7
  s_add_u32 s54, s54, 1150976
  v_mfma_f32_16x16x32_bf16 v[56:59], v[88:91], v[28:31], v[56:59]
  v_mfma_f32_16x16x32_bf16 v[60:63], v[104:107], v[28:31], v[60:63]
  v_mfma_f32_16x16x32_bf16 v[64:67], v[120:123], v[28:31], v[64:67]
  v_mfma_f32_16x16x32_bf16 v[68:71], v[136:139], v[28:31], v[68:71]
  v_mfma_f32_16x16x32_bf16 v[72:75], v[152:155], v[28:31], v[72:75]
  v_mfma_f32_16x16x32_bf16 v[56:59], v[92:95], v[32:35], v[56:59]
  v_mfma_f32_16x16x32_bf16 v[60:63], v[108:111], v[32:35], v[60:63]
  v_mfma_f32_16x16x32_bf16 v[64:67], v[124:127], v[32:35], v[64:67]
  v_mfma_f32_16x16x32_bf16 v[68:71], v[140:143], v[32:35], v[68:71]
  v_mfma_f32_16x16x32_bf16 v[72:75], v[156:159], v[32:35], v[72:75]
  v_mfma_f32_16x16x32_bf16 v[56:59], v[96:99], v[36:39], v[56:59]
  v_mfma_f32_16x16x32_bf16 v[60:63], v[112:115], v[36:39], v[60:63]
  v_mfma_f32_16x16x32_bf16 v[64:67], v[128:131], v[36:39], v[64:67]
  v_mfma_f32_16x16x32_bf16 v[68:71], v[144:147], v[36:39], v[68:71]
  v_mfma_f32_16x16x32_bf16 v[72:75], v[160:163], v[36:39], v[72:75]
  v_mfma_f32_16x16x32_bf16 v[56:59], v[100:103], v[40:43], v[56:59]
  v_mfma_f32_16x16x32_bf16 v[60:63], v[116:119], v[40:43], v[60:63]
  v_mfma_f32_16x16x32_bf16 v[64:67], v[132:135], v[40:43], v[64:67]
  v_mfma_f32_16x16x32_bf16 v[68:71], v[148:151], v[40:43], v[68:71]
  v_mfma_f32_16x16x32_bf16 v[72:75], v[164:167], v[40:43], v[72:75]
  s_nop 3
  s_nop 3
  v_and_or_b32 v56, v56, s56, v8
  v_and_or_b32 v57, v57, s56, v8
  v_and_or_b32 v58, v58, s56, v8
  v_and_or_b32 v59, v59, s56, v8
  buffer_store_dwordx4 v[56:59], v20, s[44:47], s54 offen sc1
  s_add_u32 s54, s54, 294912
  v_and_or_b32 v60, v60, s56, v8
  v_and_or_b32 v61, v61, s56, v8
  v_and_or_b32 v62, v62, s56, v8
  v_and_or_b32 v63, v63, s56, v8
  buffer_store_dwordx4 v[60:63], v20, s[44:47], s54 offen sc1
  s_add_u32 s54, s54, 294912
  v_and_or_b32 v64, v64, s56, v8
  v_and_or_b32 v65, v65, s56, v8
  v_and_or_b32 v66, v66, s56, v8
  v_and_or_b32 v67, v67, s56, v8
  buffer_store_dwordx4 v[64:67], v20, s[44:47], s54 offen sc1
  s_add_u32 s54, s54, 294912
  v_and_or_b32 v68, v68, s56, v8
  v_and_or_b32 v69, v69, s56, v8
  v_and_or_b32 v70, v70, s56, v8
  v_and_or_b32 v71, v71, s56, v8
  buffer_store_dwordx4 v[68:71], v20, s[44:47], s54 offen sc1
  s_add_u32 s54, s54, 294912
  v_and_or_b32 v72, v72, s56, v8
  v_and_or_b32 v73, v73, s56, v8
  v_and_or_b32 v74, v74, s56, v8
  v_and_or_b32 v75, v75, s56, v8
  s_mov_b32 exec_hi, 0
  buffer_store_dwordx4 v[72:75], v20, s[44:47], s54 offen sc1
  s_mov_b64 exec, -1
  s_waitcnt lgkmcnt(0)
  s_mov_b64 exec, 1
  ds_add_u32 v1, v2 offset:28
  s_mov_b64 exec, -1
  s_waitcnt lgkmcnt(0)
  s_endpgm
Lattn:
  s_sub_u32 s48, s3, 1
  v_mov_b32 v1, 162096
  v_mov_b32 v2, 1
  s_mov_b32 s49, -1000
  s_mov_b32 s53, 0xfffff000
  v_lshrrev_b32 v5, 4, v0
  v_and_b32 v6, 15, v0
  v_and_b32 v3, 7, v6
  v_lshlrev_b32 v3, 1, v3
  v_xor_b32 v3, v5, v3
  v_lshlrev_b32 v3, 4, v3
  v_lshl_add_u32 v3, v6, 8, v3
  s_lshl_b32 s50, s48, 13
  v_add_u32 v8, s50, v3
  v_xor_b32 v9, 64, v8
  v_xor_b32 v10, 0x80, v8
  v_xor_b32 v11, 0xc0, v8
  v_and_b32 v3, 1, v6
  s_movk_i32 s50, 272
  v_mul_lo_u32 v12, v3, s50
  v_lshl_add_u32 v12, v5, 4, v12
  v_add_u32 v12, 160016, v12
  s_movk_i32 s50, 576
  v_mul_lo_u32 v14, v3, s50
  v_lshl_add_u32 v14, v5, 4, v14
  v_add_u32 v14, 160560, v14
  v_lshrrev_b32 v15, 2, v6
  v_lshl_add_u32 v15, v5, 2, v15
  v_and_b32 v16, 7, v15
  v_lshlrev_b32 v16, 1, v16
  v_bfe_u32 v17, v6, 1, 1
  s_lshl_b32 s50, s48, 1
  v_add_u32 v17, s50, v17
  v_xor_b32 v17, v17, v16
  v_lshlrev_b32 v17, 4, v17
  v_lshl_add_u32 v13, v15, 8, v17
  v_and_b32 v16, 1, v6
  v_lshl_add_u32 v13, v16, 3, v13
  v_add_u32 v13, 69632, v13
  v_mov_b32 v4, s41
  s_mul_i32 s55, s40, -8
  s_add_u32 s55, s55, 17
  s_lshr_b32 s56, s55, 1
  s_cmp_lt_u32 s48, s56
  s_cselect_b32 s57, 1, 0
  s_and_b32 s50, s56, 7
  s_cmp_eq_u32 s48, s50
  s_cselect_b32 s58, 1, 0
  s_lshl_b32 s59, s55, 2
  s_add_u32 s59, s59, 21
  s_sub_u32 s60, s55, 1
  s_lshl_b32 s60, s60, 12
  v_mov_b32 v68, 0xff800000
  v_mov_b32 v69, 0xff800000
  v_mov_b32 v70, 0xff800000
  v_mov_b32 v71, 0xff800000
  v_mov_b32 v72, 0xff800000
  v_mov_b32 v73, 0xff800000
  v_mov_b32 v74, 0xff800000
  v_mov_b32 v75, 0xff800000
  v_mov_b32 v76, 0xff800000
  v_mov_b32 v77, 0xff800000
  v_mov_b32 v78, 0xff800000
  v_mov_b32 v79, 0xff800000
  v_mov_b32 v132, 0
  s_mov_b32 s61, 0
  s_cmp_eq_u32 s57, 0
  s_cbranch_scc1 Lnp_74
  s_lshl_b32 s52, s48, 3
  s_add_u32 s52, s52, 29
Lwf_75:
  s_cmp_ge_i32 s49, s52
  s_cbranch_scc1 Lwfd_76
  s_add_u32 s18, s18, 1
  s_cmp_gt_u32 s18, 4194304
  s_cbranch_scc1 Lend
  ds_read_b32 v3, v1 offset:0
  s_waitcnt lgkmcnt(0)
  v_readfirstlane_b32 s49, v3
  s_branch Lwf_75
Lwfd_76:
  ds_read_b128 v[36:39], v8 offset:0
  ds_read_b128 v[40:43], v9 offset:0
  ds_read_b128 v[44:47], v10 offset:0
  ds_read_b128 v[48:51], v11 offset:0
  ds_read_b128 v[52:55], v8 offset:4096
  ds_read_b128 v[56:59], v9 offset:4096
  ds_read_b128 v[60:63], v10 offset:4096
  ds_read_b128 v[64:67], v11 offset:4096
Lnp_74:
  s_cmp_eq_u32 s58, 0
  s_cbranch_scc1 Lnh_77
Lwf_78:
  s_cmp_ge_i32 s49, s59
  s_cbranch_scc1 Lwfd_79
  s_add_u32 s18, s18, 1
  s_cmp_gt_u32 s18, 4194304
  s_cbranch_scc1 Lend
  ds_read_b32 v3, v1 offset:0
  s_waitcnt lgkmcnt(0)
  v_readfirstlane_b32 s49, v3
  s_branch Lwf_78
Lwfd_79:
  s_lshl_b32 s50, s48, 13
  s_sub_u32 s50, s60, s50
  v_add_u32 v16, s50, v8
  v_add_u32 v17, s50, v9
  v_add_u32 v18, s50, v10
  v_add_u32 v19, s50, v11
  ds_read_b128 v[116:119], v16
  ds_read_b128 v[120:123], v17
  ds_read_b128 v[124:127], v18
  ds_read_b128 v[128:131], v19
Lnh_77:
  s_waitcnt lgkmcnt(0)
  s_mov_b64 exec, 1
  ds_add_u32 v1, v2 offset:32
  s_mov_b64 exec, -1
Lw1_80:
  s_add_u32 s18, s18, 1
  s_cmp_gt_u32 s18, 4194304
  s_cbranch_scc1 Lend
  ds_read_b32 v3, v1 offset:8
  s_waitcnt lgkmcnt(0)
  v_readfirstlane_b32 s50, v3
  s_cmp_ge_i32 s50, 1
  s_cbranch_scc0 Lw1_80
  ds_read_b128 v[20:23], v12 offset:0
  ds_read_b128 v[24:27], v12 offset:64
  ds_read_b128 v[28:31], v12 offset:128
  ds_read_b128 v[32:35], v12 offset:192
  s_cmp_eq_u32 s57, 0
  s_cbranch_scc1 Lnp_81
  s_waitcnt lgkmcnt(3)
  v_mfma_f32_16x16x32_bf16 v[68:71], v[36:39], v[20:23], 0
  s_waitcnt lgkmcnt(2)
  v_mfma_f32_16x16x32_bf16 v[68:71], v[40:43], v[24:27], v[68:71]
  s_waitcnt lgkmcnt(1)
  v_mfma_f32_16x16x32_bf16 v[68:71], v[44:47], v[28:31], v[68:71]
  s_waitcnt lgkmcnt(0)
  v_mfma_f32_16x16x32_bf16 v[68:71], v[48:51], v[32:35], v[68:71]
  v_mfma_f32_16x16x32_bf16 v[72:75], v[52:55], v[20:23], 0
  v_mfma_f32_16x16x32_bf16 v[72:75], v[56:59], v[24:27], v[72:75]
  v_mfma_f32_16x16x32_bf16 v[72:75], v[60:63], v[28:31], v[72:75]
  v_mfma_f32_16x16x32_bf16 v[72:75], v[64:67], v[32:35], v[72:75]
Lnp_81:
  s_cmp_eq_u32 s58, 0
  s_cbranch_scc1 Lnh_82
  s_waitcnt lgkmcnt(0)
  v_mfma_f32_16x16x32_bf16 v[76:79], v[116:119], v[20:23], 0
  v_mfma_f32_16x16x32_bf16 v[76:79], v[120:123], v[24:27], v[76:79]
  v_mfma_f32_16x16x32_bf16 v[76:79], v[124:127], v[28:31], v[76:79]
  v_mfma_f32_16x16x32_bf16 v[76:79], v[128:131], v[32:35], v[76:79]
Lnh_82:
  s_waitcnt lgkmcnt(0)
  s_nop 7
  v_cvt_pk_bf16_f32 v20, v68, v69
  v_cvt_pk_bf16_f32 v21, v70, v71
  v_cvt_pk_bf16_f32 v22, v72, v73
  v_cvt_pk_bf16_f32 v23, v74, v75
  v_cvt_pk_bf16_f32 v24, v76, v77
  v_cvt_pk_bf16_f32 v25, v78, v79
  v_lshlrev_b32 v68, 16, v20
  v_and_b32 v69, 0xffff0000, v20
  v_lshlrev_b32 v70, 16, v21
  v_and_b32 v71, 0xffff0000, v21
  v_lshlrev_b32 v72, 16, v22
  v_and_b32 v73, 0xffff0000, v22
  v_lshlrev_b32 v74, 16, v23
  v_and_b32 v75, 0xffff0000, v23
  v_lshlrev_b32 v76, 16, v24
  v_and_b32 v77, 0xffff0000, v24
  v_lshlrev_b32 v78, 16, v25
  v_and_b32 v79, 0xffff0000, v25
  v_mul_f32 v68, 0x3db504f3, v68
  v_mul_f32 v69, 0x3db504f3, v69
  v_mul_f32 v70, 0x3db504f3, v70
  v_mul_f32 v71, 0x3db504f3, v71
  v_mul_f32 v72, 0x3db504f3, v72
  v_mul_f32 v73, 0x3db504f3, v73
  v_mul_f32 v74, 0x3db504f3, v74
  v_mul_f32 v75, 0x3db504f3, v75
  v_mul_f32 v76, 0x3db504f3, v76
  v_mul_f32 v77, 0x3db504f3, v77
  v_mul_f32 v78, 0x3db504f3, v78
  v_mul_f32 v79, 0x3db504f3, v79
  v_cvt_pk_bf16_f32 v20, v68, v69
  v_cvt_pk_bf16_f32 v21, v70, v71
  v_cvt_pk_bf16_f32 v22, v72, v73
  v_cvt_pk_bf16_f32 v23, v74, v75
  v_cvt_pk_bf16_f32 v24, v76, v77
  v_cvt_pk_bf16_f32 v25, v78, v79
  v_lshlrev_b32 v68, 16, v20
  v_and_b32 v69, 0xffff0000, v20
  v_lshlrev_b32 v70, 16, v21
  v_and_b32 v71, 0xffff0000, v21
  v_lshlrev_b32 v72, 16, v22
  v_and_b32 v73, 0xffff0000, v22
  v_lshlrev_b32 v74, 16, v23
  v_and_b32 v75, 0xffff0000, v23
  v_lshlrev_b32 v76, 16, v24
  v_and_b32 v77, 0xffff0000, v24
  v_lshlrev_b32 v78, 16, v25
  v_and_b32 v79, 0xffff0000, v25
  v_max3_f32 v15, v68, v69, v70
  v_max3_f32 v16, v71, v72, v73
  v_max3_f32 v17, v74, v75, v76
  v_max3_f32 v18, v77, v78, v79
  v_max3_f32 v15, v15, v16, v17
  v_max_f32 v15, v15, v18
  v_mov_b32 v25, v15
  s_nop 1
  v_permlane16_swap_b32 v15, v25
  s_nop 1
  v_max_f32 v15, v15, v25
  v_mov_b32 v25, v15
  s_nop 1
  v_permlane32_swap_b32 v15, v25
  s_nop 1
  v_max_f32 v15, v15, v25
  v_and_b32 v3, 1, v0
  v_lshlrev_b32 v26, 5, v3
  s_lshl_b32 s50, s48, 2
  v_add_u32 v27, s50, v26
  v_add_u32 v27, 161712, v27
  v_add_u32 v26, 161712, v26
  s_mov_b64 exec, 3
  ds_write_b32 v27, v15
  s_mov_b64 exec, -1
  s_waitcnt lgkmcnt(0)
  s_mov_b64 exec, 1
  ds_add_u32 v1, v2 offset:12
  s_mov_b64 exec, -1
Lw1_83:
  s_add_u32 s18, s18, 1
  s_cmp_gt_u32 s18, 4194304
  s_cbranch_scc1 Lend
  ds_read_b32 v3, v1 offset:12
  s_waitcnt lgkmcnt(0)
  v_readfirstlane_b32 s50, v3
  s_cmp_ge_i32 s50, 8
  s_cbranch_scc0 Lw1_83
  ds_read_b128 v[28:31], v26
  ds_read_b128 v[32:35], v26 offset:16
  s_waitcnt lgkmcnt(0)
  v_max3_f32 v15, v28, v29, v30
  v_max3_f32 v15, v15, v31, v32
  v_max3_f32 v15, v15, v33, v34
  v_max_f32 v15, v15, v35
  v_mul_f32 v25, 0x3fb8aa3b, v15
  v_fma_f32 v68, v68, s54, -v25
  v_fma_f32 v69, v69, s54, -v25
  v_fma_f32 v70, v70, s54, -v25
  v_fma_f32 v71, v71, s54, -v25
  v_fma_f32 v72, v72, s54, -v25
  v_fma_f32 v73, v73, s54, -v25
  v_fma_f32 v74, v74, s54, -v25
  v_fma_f32 v75, v75, s54, -v25
  v_fma_f32 v76, v76, s54, -v25
  v_fma_f32 v77, v77, s54, -v25
  v_fma_f32 v78, v78, s54, -v25
  v_fma_f32 v79, v79, s54, -v25
  v_exp_f32 v68, v68
  v_exp_f32 v69, v69
  v_exp_f32 v70, v70
  v_exp_f32 v71, v71
  v_exp_f32 v72, v72
  v_exp_f32 v73, v73
  v_exp_f32 v74, v74
  v_exp_f32 v75, v75
  v_exp_f32 v76, v76
  v_exp_f32 v77, v77
  v_exp_f32 v78, v78
  v_exp_f32 v79, v79
  s_nop 0
  v_add_f32 v28, v68, v69
  v_add_f32 v29, v70, v71
  v_add_f32 v30, v72, v73
  v_add_f32 v31, v74, v75
  v_add_f32 v20, v76, v77
  v_add_f32 v21, v78, v79
  v_add_f32 v28, v28, v29
  v_add_f32 v30, v30, v31
  v_add_f32 v20, v20, v21
  v_add_f32 v28, v28, v30
  v_add_f32 v28, v28, v20
  v_cvt_pk_bf16_f32 v32, v68, v69
  v_cvt_pk_bf16_f32 v33, v70, v71
  v_cvt_pk_bf16_f32 v34, v72, v73
  v_cvt_pk_bf16_f32 v35, v74, v75
  v_cvt_pk_bf16_f32 v22, v76, v77
  v_cvt_pk_bf16_f32 v23, v78, v79
  v_mov_b32 v29, v28
  s_nop 1
  v_permlane16_swap_b32 v28, v29
  s_nop 1
  v_add_f32 v28, v28, v29
  v_mov_b32 v29, v28
  s_nop 1
  v_permlane32_swap_b32 v28, v29
  s_nop 1
  v_add_f32 v28, v28, v29
  s_lshl_b32 s50, s48, 6
  v_add_u32 v30, s50, v14
  v_lshlrev_b32 v19, 3, v5
  v_sub_u32 v19, v14, v19
  v_add_u32 v19, 512, v19
  s_mov_b32 exec_lo, 0x00030003
  s_mov_b32 exec_hi, 0x00030003
  s_cmp_eq_u32 s57, 0
  s_cbranch_scc1 Lnp_84
  ds_write_b128 v30, v[32:35]
Lnp_84:
  s_cmp_eq_u32 s58, 0
  s_cbranch_scc1 Lnh_85
  ds_write_b64 v19, v[22:23]
Lnh_85:
  s_mov_b64 exec, 3
  ds_write_b32 v27, v28 offset:64
  s_mov_b64 exec, -1
  s_waitcnt lgkmcnt(0)
  s_mov_b64 exec, 1
  ds_add_u32 v1, v2 offset:16
  s_mov_b64 exec, -1
  v_and_b32 v133, 1, v0
  v_lshlrev_b32 v133, 6, v133
  v_lshl_add_u32 v133, v5, 4, v133
  s_lshl_b32 s62, s34, 14
  s_lshl_b32 s63, s48, 11
  s_add_u32 s62, s62, s63
  s_lshl_b32 s63, s36, 10
  s_add_u32 s62, s62, s63
  s_lshl_b32 s63, s37, 7
  s_add_u32 s62, s62, s63
  s_add_u32 s62, s62, 266240
  v_add_u32 v16, s60, v13
  s_add_u32 s52, s59, 8
Lwf_87:
  s_cmp_ge_i32 s49, s52
  s_cbranch_scc1 Lwfd_88
  s_add_u32 s18, s18, 1
  s_cmp_gt_u32 s18, 4194304
  s_cbranch_scc1 Lend
  ds_read_b32 v3, v1 offset:0
  s_waitcnt lgkmcnt(0)
  v_readfirstlane_b32 s49, v3
  s_branch Lwf_87
Lwfd_88:
  ds_read_b64_tr_b16 v[80:81], v13 offset:0
  ds_read_b64_tr_b16 v[82:83], v13 offset:4096
  s_add_u32 s52, s59, 16
Lwf_89:
  s_cmp_ge_i32 s49, s52
  s_cbranch_scc1 Lwfd_90
  s_add_u32 s18, s18, 1
  s_cmp_gt_u32 s18, 4194304
  s_cbranch_scc1 Lend
  ds_read_b32 v3, v1 offset:0
  s_waitcnt lgkmcnt(0)
  v_readfirstlane_b32 s49, v3
  s_branch Lwf_89
Lwfd_90:
  ds_read_b64_tr_b16 v[84:85], v13 offset:8192
  ds_read_b64_tr_b16 v[86:87], v13 offset:12288
  s_add_u32 s52, s59, 24
Lwf_91:
  s_cmp_ge_i32 s49, s52
  s_cbranch_scc1 Lwfd_92
  s_add_u32 s18, s18, 1
  s_cmp_gt_u32 s18, 4194304
  s_cbranch_scc1 Lend
  ds_read_b32 v3, v1 offset:0
  s_waitcnt lgkmcnt(0)
  v_readfirstlane_b32 s49, v3
  s_branch Lwf_91
Lwfd_92:
  ds_read_b64_tr_b16 v[88:89], v13 offset:16384
  ds_read_b64_tr_b16 v[90:91], v13 offset:20480
  s_add_u32 s52, s59, 32
Lwf_93:
  s_cmp_ge_i32 s49, s52
  s_cbranch_scc1 Lwfd_94
  s_add_u32 s18, s18, 1
  s_cmp_gt_u32 s18, 4194304
  s_cbranch_scc1 Lend
  ds_read_b32 v3, v1 offset:0
  s_waitcnt lgkmcnt(0)
  v_readfirstlane_b32 s49, v3
  s_branch Lwf_93
Lwfd_94:
  ds_read_b64_tr_b16 v[92:93], v13 offset:24576
  ds_read_b64_tr_b16 v[94:95], v13 offset:28672
Lw1_95:
  s_add_u32 s18, s18, 1
  s_cmp_gt_u32 s18, 4194304
  s_cbranch_scc1 Lend
  ds_read_b32 v3, v1 offset:16
  s_waitcnt lgkmcnt(0)
  v_readfirstlane_b32 s50, v3
  s_cmp_ge_i32 s50, 8
  s_cbranch_scc0 Lw1_95
  ds_read_b128 v[36:39], v14 offset:0
  ds_read_b128 v[40:43], v14 offset:64
  ds_read_b128 v[44:47], v14 offset:128
  ds_read_b128 v[48:51], v14 offset:192
  ds_read_b128 v[52:55], v14 offset:256
  ds_read_b128 v[56:59], v14 offset:320
  ds_read_b128 v[60:63], v14 offset:384
  ds_read_b128 v[64:67], v14 offset:448
  ds_read_b64 v[114:115], v19
  s_waitcnt lgkmcnt(0)
  v_mfma_f32_16x16x32_bf16 v[68:71], v[80:83], v[36:39], 0
  v_mfma_f32_16x16x32_bf16 v[68:71], v[84:87], v[40:43], v[68:71]
  v_mfma_f32_16x16x32_bf16 v[68:71], v[88:91], v[44:47], v[68:71]
  v_mfma_f32_16x16x32_bf16 v[68:71], v[92:95], v[48:51], v[68:71]
  s_cmp_lg_u32 s48, 0
  s_cbranch_scc1 Lst_96
  ds_read_b128 v[28:31], v26 offset:64
  ds_read_b128 v[32:35], v26 offset:80
  s_waitcnt lgkmcnt(0)
  v_add_f32 v28, v28, v29
  v_add_f32 v30, v30, v31
  v_add_f32 v32, v32, v33
  v_add_f32 v34, v34, v35
  v_add_f32 v28, v28, v30
  v_add_f32 v32, v32, v34
  v_add_f32 v29, v28, v32
  v_mov_b32 v28, v15
  v_mov_b32 v30, 0
  v_mov_b32 v31, 0
  v_and_or_b32 v28, v28, s53, v4
  v_and_or_b32 v29, v29, s53, v4
  v_and_or_b32 v30, v30, s53, v4
  v_and_or_b32 v31, v31, s53, v4
  v_lshlrev_b32 v3, 4, v0
  s_lshl_b32 s50, s34, 11
  s_lshl_b32 s51, s36, 10
  s_add_u32 s50, s50, s51
  s_lshl_b32 s51, s37, 7
  s_add_u32 s50, s50, s51
  s_add_u32 s50, s50, 528384
  v_mov_b32 v132, v3
  s_mov_b32 s61, s50
Lst_96:
  s_cmp_le_u32 s56, 4
  s_cbranch_scc1 Lvh_86
  s_add_u32 s52, s59, 40
Lwf_97:
  s_cmp_ge_i32 s49, s52
  s_cbranch_scc1 Lwfd_98
  s_add_u32 s18, s18, 1
  s_cmp_gt_u32 s18, 4194304
  s_cbranch_scc1 Lend
  ds_read_b32 v3, v1 offset:0
  s_waitcnt lgkmcnt(0)
  v_readfirstlane_b32 s49, v3
  s_branch Lwf_97
Lwfd_98:
  ds_read_b64_tr_b16 v[96:97], v13 offset:32768
  ds_read_b64_tr_b16 v[98:99], v13 offset:36864
  s_waitcnt lgkmcnt(0)
  v_mfma_f32_16x16x32_bf16 v[68:71], v[96:99], v[52:55], v[68:71]
  s_cmp_le_u32 s56, 5
  s_cbranch_scc1 Lvh_86
  s_add_u32 s52, s59, 48
Lwf_99:
  s_cmp_ge_i32 s49, s52
  s_cbranch_scc1 Lwfd_100
  s_add_u32 s18, s18, 1
  s_cmp_gt_u32 s18, 4194304
  s_cbranch_scc1 Lend
  ds_read_b32 v3, v1 offset:0
  s_waitcnt lgkmcnt(0)
  v_readfirstlane_b32 s49, v3
  s_branch Lwf_99
Lwfd_100:
  ds_read_b64_tr_b16 v[100:101], v13 offset:40960
  ds_read_b64_tr_b16 v[102:103], v13 offset:45056
  s_waitcnt lgkmcnt(0)
  v_mfma_f32_16x16x32_bf16 v[68:71], v[100:103], v[56:59], v[68:71]
  s_cmp_le_u32 s56, 6
  s_cbranch_scc1 Lvh_86
  s_add_u32 s52, s59, 56
Lwf_101:
  s_cmp_ge_i32 s49, s52
  s_cbranch_scc1 Lwfd_102
  s_add_u32 s18, s18, 1
  s_cmp_gt_u32 s18, 4194304
  s_cbranch_scc1 Lend
  ds_read_b32 v3, v1 offset:0
  s_waitcnt lgkmcnt(0)
  v_readfirstlane_b32 s49, v3
  s_branch Lwf_101
Lwfd_102:
  ds_read_b64_tr_b16 v[104:105], v13 offset:49152
  ds_read_b64_tr_b16 v[106:107], v13 offset:53248
  s_waitcnt lgkmcnt(0)
  v_mfma_f32_16x16x32_bf16 v[68:71], v[104:107], v[60:63], v[68:71]
  s_cmp_le_u32 s56, 7
  s_cbranch_scc1 Lvh_86
  s_add_u32 s52, s59, 64
Lwf_103:
  s_cmp_ge_i32 s49, s52
  s_cbranch_scc1 Lwfd_104
  s_add_u32 s18, s18, 1
  s_cmp_gt_u32 s18, 4194304
  s_cbranch_scc1 Lend
  ds_read_b32 v3, v1 offset:0
  s_waitcnt lgkmcnt(0)
  v_readfirstlane_b32 s49, v3
  s_branch Lwf_103
Lwfd_104:
  ds_read_b64_tr_b16 v[108:109], v13 offset:57344
  ds_read_b64_tr_b16 v[110:111], v13 offset:61440
  s_waitcnt lgkmcnt(0)
  v_mfma_f32_16x16x32_bf16 v[68:71], v[108:111], v[64:67], v[68:71]
Lvh_86:
  s_lshl_b32 s52, s55, 2
  s_add_u32 s52, s52, s59
Lwf_105:
  s_cmp_ge_i32 s49, s52
  s_cbranch_scc1 Lwfd_106
  s_add_u32 s18, s18, 1
  s_cmp_gt_u32 s18, 4194304
  s_cbranch_scc1 Lend
  ds_read_b32 v3, v1 offset:0
  s_waitcnt lgkmcnt(0)
  v_readfirstlane_b32 s49, v3
  s_branch Lwf_105
Lwfd_106:
  ds_read_b64_tr_b16 v[112:113], v16
  s_nop 3
  s_waitcnt lgkmcnt(0)
  v_mfma_f32_16x16x16_bf16 v[68:71], v[112:113], v[114:115], v[68:71]
  v_mov_b32 v3, v133
  s_mov_b32 s50, s62
  s_nop 5
  v_and_or_b32 v68, v68, s53, v4
  v_and_or_b32 v69, v69, s53, v4
  v_and_or_b32 v70, v70, s53, v4
  v_and_or_b32 v71, v71, s53, v4
  s_mov_b32 exec_lo, 0x00030003
  s_mov_b32 exec_hi, 0x00030003
  buffer_store_dwordx4 v[68:71], v3, s[44:47], s50 offen sc1
  s_mov_b64 exec, -1
  s_waitcnt lgkmcnt(0)
  s_mov_b64 exec, 1
  ds_add_u32 v1, v2 offset:20
  s_mov_b64 exec, -1
  s_cmp_lg_u32 s48, 0
  s_cbranch_scc1 Lls_107
  s_mov_b64 exec, 0xff
  buffer_store_dwordx4 v[28:31], v132, s[44:47], s61 offen sc1
  s_mov_b64 exec, -1
Lls_107:
Lw1_108:
  s_add_u32 s18, s18, 1
  s_cmp_gt_u32 s18, 4194304
  s_cbranch_scc1 Lend
  ds_read_b32 v3, v1 offset:20
  s_waitcnt lgkmcnt(0)
  v_readfirstlane_b32 s50, v3
  s_cmp_ge_i32 s50, 8
  s_cbranch_scc0 Lw1_108
  s_lshl_b32 s55, s34, 14
  s_lshl_b32 s50, s37, 11
  s_add_u32 s55, s55, s50
  s_lshl_b32 s50, s36, 6
  s_add_u32 s55, s55, s50
  s_lshl_b32 s50, s48, 8
  s_add_u32 s55, s55, s50
  s_add_u32 s55, s55, 266240
  s_add_u32 s56, s30, s55
  s_addc_u32 s57, s31, 0
  s_lshl_b32 s55, s34, 11
  s_add_u32 s55, s55, s50
  s_lshl_b32 s50, s36, 4
  s_add_u32 s55, s55, s50
  s_add_u32 s55, s55, 528384
  s_add_u32 s58, s30, s55
  s_addc_u32 s59, s31, 0
  s_mul_i32 s50, s48, 160
  s_add_u32 s50, s50, 132096
  v_lshlrev_b32 v22, 2, v0
  v_add_u32 v22, s50, v22
  v_mov_b32 v20, 0
  s_mov_b32 s50, s41
Lsg_109:
  s_add_u32 s18, s18, 128
  s_cmp_gt_u32 s18, 4194304
  s_cbranch_scc1 Lsgx_110
  s_load_dwordx16 s[64:79], s[56:57], 0 glc
  s_load_dwordx4 s[80:83], s[58:59], 0 glc
  s_load_dwordx16 s[84:99], s[56:57], 128 glc
  s_load_dwordx4 s[60:63], s[58:59], 128 glc
  s_waitcnt lgkmcnt(0)
  s_xor_b32 s51, s64, s50
  s_xor_b32 s52, s79, s50
  s_or_b32 s51, s51, s52
  s_xor_b32 s52, s80, s50
  s_or_b32 s51, s51, s52
  s_xor_b32 s52, s84, s50
  s_or_b32 s51, s51, s52
  s_xor_b32 s52, s99, s50
  s_or_b32 s51, s51, s52
  s_xor_b32 s52, s60, s50
  s_or_b32 s51, s51, s52
  s_and_b32 s51, s51, 0xfff
  s_cbranch_scc1 Lsg_109
  v_writelane_b32 v20, s64, 0
  v_writelane_b32 v20, s65, 1
  v_writelane_b32 v20, s66, 2
  v_writelane_b32 v20, s67, 3
  v_writelane_b32 v20, s68, 4
  v_writelane_b32 v20, s69, 5
  v_writelane_b32 v20, s70, 6
  v_writelane_b32 v20, s71, 7
  v_writelane_b32 v20, s72, 8
  v_writelane_b32 v20, s73, 9
  v_writelane_b32 v20, s74, 10
  v_writelane_b32 v20, s75, 11
  v_writelane_b32 v20, s76, 12
  v_writelane_b32 v20, s77, 13
  v_writelane_b32 v20, s78, 14
  v_writelane_b32 v20, s79, 15
  v_writelane_b32 v20, s80, 16
  v_writelane_b32 v20, s81, 17
  v_writelane_b32 v20, s82, 18
  v_writelane_b32 v20, s83, 19
  v_writelane_b32 v20, s84, 20
  v_writelane_b32 v20, s85, 21
  v_writelane_b32 v20, s86, 22
  v_writelane_b32 v20, s87, 23
  v_writelane_b32 v20, s88, 24
  v_writelane_b32 v20, s89, 25
  v_writelane_b32 v20, s90, 26
  v_writelane_b32 v20, s91, 27
  v_writelane_b32 v20, s92, 28
  v_writelane_b32 v20, s93, 29
  v_writelane_b32 v20, s94, 30
  v_writelane_b32 v20, s95, 31
  v_writelane_b32 v20, s96, 32
  v_writelane_b32 v20, s97, 33
  v_writelane_b32 v20, s98, 34
  v_writelane_b32 v20, s99, 35
  v_writelane_b32 v20, s60, 36
  v_writelane_b32 v20, s61, 37
  v_writelane_b32 v20, s62, 38
  v_writelane_b32 v20, s63, 39
  s_mov_b32 exec_lo, 0xffffffff
  s_mov_b32 exec_hi, 0xff
  v_xor_b32 v21, v20, v4
  v_and_b32 v21, 0xfff, v21
  v_cmp_ne_u32 vcc, 0, v21
  s_nop 1
  s_cbranch_vccz Lsgx_110
  s_mov_b64 exec, -1
  s_branch Lsg_109
Lsgx_110:
  ds_write_b32 v22, v20
  s_mov_b64 exec, -1
  s_waitcnt lgkmcnt(0)
  s_mov_b64 exec, 1
  ds_add_u32 v1, v2 offset:44
  s_mov_b64 exec, -1
  s_cmp_le_u32 s48, 4
  s_cbranch_scc1 Lblk
  s_endpgm
Lblk:
  v_and_b32 v3, 1, v0
  v_mov_b32 v12, 0xffff
  v_lshlrev_b32 v3, 4, v3
  v_lshlrev_b32 v12, v3, v12
  v_bfe_u32 v3, v0, 1, 2
  v_cmp_eq_u32 vcc, 0, v3
  s_nop 1
  v_cndmask_b32 v8, 0, v12, vcc
  v_cmp_eq_u32 vcc, 1, v3
  s_nop 1
  v_cndmask_b32 v9, 0, v12, vcc
  v_cmp_eq_u32 vcc, 2, v3
  s_nop 1
  v_cndmask_b32 v10, 0, v12, vcc
  v_cmp_eq_u32 vcc, 3, v3
  s_nop 1
  v_cndmask_b32 v11, 0, v12, vcc
  v_and_b32 v13, 15, v0
  v_mul_u32_u24 v13, 80, v13
  v_add_u32 v13, 132096, v13
  v_lshl_add_u32 v14, v5, 4, v13
  v_lshlrev_b32 v17, 4, v0
  s_lshl_b32 s50, s48, 12
  v_add_u32 v17, s50, v17
  v_and_b32 v18, 7, v0
  v_lshl_add_u32 v18, v5, 4, v18
  v_lshlrev_b32 v18, 4, v18
  v_add_u32 v18, 16384, v18
  s_cmp_eq_u32 s48, 4
  s_cselect_b64 vcc, -1, 0
  s_lshl_b32 s57, s48, 2
  s_add_u32 s57, s57, 4
  s_cmp_eq_u32 s48, 4
  s_cselect_b32 s57, 18, s57
  v_cndmask_b32 v17, v17, v18, vcc
  s_mul_i32 s55, s40, 88064
  s_add_u32 s55, s55, 18432
  v_add_u32 v18, s55, v17
  s_mul_i32 s55, s40, 51200
  s_add_u32 s55, s55, 36864
  v_add_u32 v19, s55, v17
  s_mul_i32 s58, s40, -28
  s_add_u32 s58, s58, 193
  s_add_u32 s58, s58, s57
  s_mul_i32 s59, s40, -10
  s_add_u32 s59, s59, 211
  s_add_u32 s59, s59, s57
  v_lshrrev_b32 v15, 3, v0
  s_mov_b32 s55, 36864
  v_mul_lo_u32 v15, v15, s55
  v_and_b32 v16, 7, v0
  v_lshl_add_u32 v15, v16, 4, v15
  s_lshl_b32 s56, s2, 7
  s_mul_i32 s55, s48, 294912
  s_add_u32 s56, s56, s55
  s_add_u32 s56, s56, 1150976
  v_bfe_u32 v16, v0, 3, 1
  v_lshlrev_b32 v16, 6, v16
  v_lshl_add_u32 v16, v5, 4, v16
  v_add_u32 v16, 161840, v16
Lwf_111:
  s_cmp_ge_i32 s49, s58
  s_cbranch_scc1 Lwfd_112
  s_add_u32 s18, s18, 1
  s_cmp_gt_u32 s18, 4194304
  s_cbranch_scc1 Lend
  ds_read_b32 v3, v1 offset:0
  s_waitcnt lgkmcnt(0)
  v_readfirstlane_b32 s49, v3
  s_branch Lwf_111
Lwfd_112:
  s_cmp_eq_u32 s48, 4
  s_cbranch_scc1 Lr4_113
  ds_read_b128 v[40:43], v18 offset:0
  ds_read_b128 v[44:47], v18 offset:1024
  ds_read_b128 v[48:51], v18 offset:2048
  ds_read_b128 v[52:55], v18 offset:3072
  s_branch Lr4_114
Lr4_113:
  ds_read_b128 v[40:43], v18 offset:0
  ds_read_b128 v[44:47], v18 offset:128
  ds_read_b128 v[48:51], v18 offset:1024
  ds_read_b128 v[52:55], v18 offset:1152
Lr4_114:
Lw1_115:
  s_add_u32 s18, s18, 1
  s_cmp_gt_u32 s18, 4194304
  s_cbranch_scc1 Lend
  ds_read_b32 v3, v1 offset:44
  s_waitcnt lgkmcnt(0)
  v_readfirstlane_b32 s50, v3
  s_cmp_ge_i32 s50, 8
  s_cbranch_scc0 Lw1_115
  ds_read_b128 v[20:23], v14
  ds_read_b64 v[24:25], v13 offset:64
  s_waitcnt lgkmcnt(0)
  v_and_b32 v20, s53, v20
  v_and_b32 v21, s53, v21
  v_and_b32 v22, s53, v22
  v_and_b32 v23, s53, v23
  v_and_b32 v24, s53, v24
  v_and_b32 v25, s53, v25
  v_mov_b32 v28, v24
  s_nop 1
  v_max_f32_dpp v28, v28, v28 quad_perm:[1,0,3,2] row_mask:0xf bank_mask:0xf
  s_nop 1
  v_max_f32_dpp v28, v28, v28 quad_perm:[2,3,0,1] row_mask:0xf bank_mask:0xf
  s_nop 1
  v_max_f32_dpp v28, v28, v28 row_half_mirror row_mask:0xf bank_mask:0xf
  v_sub_f32 v28, v24, v28
  v_mul_f32 v28, 0x3fb8aa3b, v28
  v_exp_f32 v28, v28
  s_nop 0
  v_mul_f32 v25, v25, v28
  v_mul_f32 v20, v20, v28
  v_mul_f32 v21, v21, v28
  v_mul_f32 v22, v22, v28
  v_mul_f32 v23, v23, v28
  s_nop 1
  v_add_f32_dpp v25, v25, v25 quad_perm:[1,0,3,2] row_mask:0xf bank_mask:0xf
  v_add_f32_dpp v20, v20, v20 quad_perm:[1,0,3,2] row_mask:0xf bank_mask:0xf
  v_add_f32_dpp v21, v21, v21 quad_perm:[1,0,3,2] row_mask:0xf bank_mask:0xf
  v_add_f32_dpp v22, v22, v22 quad_perm:[1,0,3,2] row_mask:0xf bank_mask:0xf
  v_add_f32_dpp v23, v23, v23 quad_perm:[1,0,3,2] row_mask:0xf bank_mask:0xf
  s_nop 1
  v_add_f32_dpp v25, v25, v25 quad_perm:[2,3,0,1] row_mask:0xf bank_mask:0xf
  v_add_f32_dpp v20, v20, v20 quad_perm:[2,3,0,1] row_mask:0xf bank_mask:0xf
  v_add_f32_dpp v21, v21, v21 quad_perm:[2,3,0,1] row_mask:0xf bank_mask:0xf
  v_add_f32_dpp v22, v22, v22 quad_perm:[2,3,0,1] row_mask:0xf bank_mask:0xf
  v_add_f32_dpp v23, v23, v23 quad_perm:[2,3,0,1] row_mask:0xf bank_mask:0xf
  s_nop 1
  v_add_f32_dpp v25, v25, v25 row_half_mirror row_mask:0xf bank_mask:0xf
  v_add_f32_dpp v20, v20, v20 row_half_mirror row_mask:0xf bank_mask:0xf
  v_add_f32_dpp v21, v21, v21 row_half_mirror row_mask:0xf bank_mask:0xf
  v_add_f32_dpp v22, v22, v22 row_half_mirror row_mask:0xf bank_mask:0xf
  v_add_f32_dpp v23, v23, v23 row_half_mirror row_mask:0xf bank_mask:0xf
  s_nop 0
  v_rcp_f32 v25, v25
  s_nop 0
  v_mul_f32 v20, v20, v25
  v_mul_f32 v21, v21, v25
  v_mul_f32 v22, v22, v25
  v_mul_f32 v23, v23, v25
  v_cvt_pk_bf16_f32 v20, v20, v20
  v_cvt_pk_bf16_f32 v21, v21, v21
  v_cvt_pk_bf16_f32 v22, v22, v22
  v_cvt_pk_bf16_f32 v23, v23, v23
  v_and_b32 v56, v20, v8
  v_and_b32 v57, v20, v9
  v_and_b32 v58, v20, v10
  v_and_b32 v59, v20, v11
  v_and_b32 v60, v21, v8
  v_and_b32 v61, v21, v9
  v_and_b32 v62, v21, v10
  v_and_b32 v63, v21, v11
  v_and_b32 v64, v22, v8
  v_and_b32 v65, v22, v9
  v_and_b32 v66, v22, v10
  v_and_b32 v67, v22, v11
  v_and_b32 v68, v23, v8
  v_and_b32 v69, v23, v9
  v_and_b32 v70, v23, v10
  v_and_b32 v71, v23, v11
  v_mfma_f32_16x16x32_bf16 v[72:75], v[40:43], v[56:59], 0
  v_mfma_f32_16x16x32_bf16 v[72:75], v[44:47], v[60:63], v[72:75]
  v_mfma_f32_16x16x32_bf16 v[72:75], v[48:51], v[64:67], v[72:75]
  v_mfma_f32_16x16x32_bf16 v[72:75], v[52:55], v[68:71], v[72:75]
Lwf_116:
  s_cmp_ge_i32 s49, s59
  s_cbranch_scc1 Lwfd_117
  s_add_u32 s18, s18, 1
  s_cmp_gt_u32 s18, 4194304
  s_cbranch_scc1 Lend
  ds_read_b32 v3, v1 offset:0
  s_waitcnt lgkmcnt(0)
  v_readfirstlane_b32 s49, v3
  s_branch Lwf_116
Lwfd_117:
  s_cmp_eq_u32 s48, 4
  s_cbranch_scc1 Lr4_118
  ds_read_b128 v[76:79], v19 offset:0
  ds_read_b128 v[80:83], v19 offset:1024
  ds_read_b128 v[84:87], v19 offset:2048
  ds_read_b128 v[88:91], v19 offset:3072
  s_branch Lr4_119
Lr4_118:
  ds_read_b128 v[76:79], v19 offset:0
  ds_read_b128 v[80:83], v19 offset:128
  ds_read_b128 v[84:87], v19 offset:1024
  ds_read_b128 v[88:91], v19 offset:1152
Lr4_119:
Lw1_120:
  s_add_u32 s18, s18, 1
  s_cmp_gt_u32 s18, 4194304
  s_cbranch_scc1 Lend
  ds_read_b32 v3, v1 offset:24
  s_waitcnt lgkmcnt(0)
  v_readfirstlane_b32 s50, v3
  s_cmp_ge_i32 s50, 1
  s_cbranch_scc0 Lw1_120
  ds_read_b128 v[20:23], v16
  s_waitcnt lgkmcnt(0)
  v_and_b32 v56, v20, v8
  v_and_b32 v57, v20, v9
  v_and_b32 v58, v20, v10
  v_and_b32 v59, v20, v11
  v_and_b32 v60, v21, v8
  v_and_b32 v61, v21, v9
  v_and_b32 v62, v21, v10
  v_and_b32 v63, v21, v11
  v_and_b32 v64, v22, v8
  v_and_b32 v65, v22, v9
  v_and_b32 v66, v22, v10
  v_and_b32 v67, v22, v11
  v_and_b32 v68, v23, v8
  v_and_b32 v69, v23, v9
  v_and_b32 v70, v23, v10
  v_and_b32 v71, v23, v11
  v_mfma_f32_16x16x32_bf16 v[72:75], v[76:79], v[56:59], v[72:75]
  v_mfma_f32_16x16x32_bf16 v[72:75], v[80:83], v[60:63], v[72:75]
  v_mfma_f32_16x16x32_bf16 v[72:75], v[84:87], v[64:67], v[72:75]
  v_mfma_f32_16x16x32_bf16 v[72:75], v[88:91], v[68:71], v[72:75]
  s_cmp_lg_u32 s48, 4
  s_cbranch_scc1 Lbs_121
  s_mov_b32 exec_hi, 0
Lbs_121:
  s_mov_b32 s55, exec_hi
  s_mov_b32 exec_hi, -1
  s_nop 3
  v_and_or_b32 v72, v72, s53, v4
  v_and_or_b32 v73, v73, s53, v4
  v_and_or_b32 v74, v74, s53, v4
  v_and_or_b32 v75, v75, s53, v4
  s_mov_b32 exec_hi, s55
  buffer_store_dwordx4 v[72:75], v15, s[44:47], s56 offen sc1
  s_mov_b64 exec, -1
  s_waitcnt lgkmcnt(0)
  s_mov_b64 exec, 1
  ds_add_u32 v1, v2 offset:28
  s_mov_b64 exec, -1
  s_cmp_lg_u32 s48, 0
  s_cbranch_scc1 Lred
  s_endpgm
Lred:
  s_cmp_ge_u32 s2, 36
  s_cbranch_scc1 Lrede_134
  s_sub_u32 s71, s48, 1
  s_lshr_b32 s57, s2, 3
  s_lshl_b32 s57, s57, 7
  s_bfe_u32 s58, s2, 0x20001
  s_lshl_b32 s58, s58, 5
  s_add_u32 s57, s57, s58
  s_and_b32 s58, s2, 1
  s_mul_i32 s58, s58, 576
  s_add_u32 s57, s57, s58
  s_lshl_b32 s57, s57, 1
  v_lshrrev_b32 v9, 2, v0
  v_and_b32 v10, 3, v0
  v_lshlrev_b32 v11, 4, v9
  v_lshl_add_u32 v11, v10, 2, v11
  v_add_u32 v11, s57, v11
  v_lshlrev_b32 v12, 5, v10
  v_lshl_add_u32 v12, v9, 2, v12
  v_add_u32 v12, 162160, v12
  s_mul_i32 s50, s2, 36864
  s_mul_i32 s51, s71, 9216
  s_add_u32 s50, s50, s51
  s_add_u32 s50, s50, 1150976
  v_lshlrev_b32 v8, 4, v0
  s_mov_b32 s64, s26
  s_mov_b32 s65, s27
  s_mov_b32 s66, 2304
  s_mov_b32 s67, 0x00020000
  s_mov_b32 s72, s8
  s_mov_b32 s73, s9
  s_mov_b32 s74, 2304
  s_mov_b32 s75, 0x00020000
  s_mov_b64 exec, 0xffff
  buffer_load_dword v13, v11, s[72:75], 0 offen
  s_mov_b64 exec, -1
  s_add_u32 s68, s40, 5
Lw1_135:
  s_add_u32 s18, s18, 1
  s_cmp_gt_u32 s18, 4194304
  s_cbranch_scc1 Lend
  ds_read_b32 v3, v1 offset:28
  s_waitcnt lgkmcnt(0)
  v_readfirstlane_b32 s51, v3
  s_cmp_ge_i32 s51, s68
  s_cbranch_scc0 Lw1_135
  s_mov_b32 s52, 0
  s_add_u32 s69, s50, 4096
  s_add_u32 s70, s50, 8192
Lg3_136:
  s_add_u32 s52, s52, 1
  s_cmp_gt_u32 s52, 32768
  s_cbranch_scc1 Lg3d_137
  buffer_load_dwordx4 v[20:23], v8, s[44:47], s50 offen offset:0 sc1
  buffer_load_dwordx4 v[24:27], v8, s[44:47], s50 offen offset:1024 sc1
  buffer_load_dwordx4 v[28:31], v8, s[44:47], s50 offen offset:2048 sc1
  buffer_load_dwordx4 v[32:35], v8, s[44:47], s50 offen offset:3072 sc1
  buffer_load_dwordx4 v[36:39], v8, s[44:47], s69 offen offset:0 sc1
  buffer_load_dwordx4 v[40:43], v8, s[44:47], s69 offen offset:1024 sc1
  buffer_load_dwordx4 v[44:47], v8, s[44:47], s69 offen offset:2048 sc1
  buffer_load_dwordx4 v[48:51], v8, s[44:47], s69 offen offset:3072 sc1
  buffer_load_dwordx4 v[52:55], v8, s[44:47], s70 offen offset:0 sc1
  s_waitcnt vmcnt(0)
  v_bitop3_b32 v61, v20, v21, v4 bitop3:0x7e
  v_bitop3_b32 v60, v22, v23, v4 bitop3:0x7e
  v_or_b32 v60, v60, v61
  v_bitop3_b32 v61, v24, v25, v4 bitop3:0x7e
  v_bitop3_b32 v62, v26, v27, v4 bitop3:0x7e
  v_or3_b32 v60, v60, v61, v62
  v_bitop3_b32 v61, v28, v29, v4 bitop3:0x7e
  v_bitop3_b32 v62, v30, v31, v4 bitop3:0x7e
  v_or3_b32 v60, v60, v61, v62
  v_bitop3_b32 v61, v32, v33, v4 bitop3:0x7e
  v_bitop3_b32 v62, v34, v35, v4 bitop3:0x7e
  v_or3_b32 v60, v60, v61, v62
  v_bitop3_b32 v61, v36, v37, v4 bitop3:0x7e
  v_bitop3_b32 v62, v38, v39, v4 bitop3:0x7e
  v_or3_b32 v60, v60, v61, v62
  v_bitop3_b32 v61, v40, v41, v4 bitop3:0x7e
  v_bitop3_b32 v62, v42, v43, v4 bitop3:0x7e
  v_or3_b32 v60, v60, v61, v62
  v_bitop3_b32 v61, v44, v45, v4 bitop3:0x7e
  v_bitop3_b32 v62, v46, v47, v4 bitop3:0x7e
  v_or3_b32 v60, v60, v61, v62
  v_bitop3_b32 v61, v48, v49, v4 bitop3:0x7e
  v_bitop3_b32 v62, v50, v51, v4 bitop3:0x7e
  v_or3_b32 v60, v60, v61, v62
  v_bitop3_b32 v61, v52, v53, v4 bitop3:0x7e
  v_bitop3_b32 v62, v54, v55, v4 bitop3:0x7e
  v_or3_b32 v60, v60, v61, v62
  v_and_b32 v60, 0xfff, v60
  v_cmp_ne_u32 vcc, 0, v60
  s_nop 1
  s_cbranch_vccnz Lg3_136
Lg3d_137:
  v_and_b32 v20, s53, v20
  v_and_b32 v21, s53, v21
  v_and_b32 v22, s53, v22
  v_and_b32 v23, s53, v23
  v_and_b32 v24, s53, v24
  v_and_b32 v25, s53, v25
  v_and_b32 v26, s53, v26
  v_and_b32 v27, s53, v27
  v_and_b32 v28, s53, v28
  v_and_b32 v29, s53, v29
  v_and_b32 v30, s53, v30
  v_and_b32 v31, s53, v31
  v_and_b32 v32, s53, v32
  v_and_b32 v33, s53, v33
  v_and_b32 v34, s53, v34
  v_and_b32 v35, s53, v35
  v_and_b32 v36, s53, v36
  v_and_b32 v37, s53, v37
  v_and_b32 v38, s53, v38
  v_and_b32 v39, s53, v39
  v_and_b32 v40, s53, v40
  v_and_b32 v41, s53, v41
  v_and_b32 v42, s53, v42
  v_and_b32 v43, s53, v43
  v_and_b32 v44, s53, v44
  v_and_b32 v45, s53, v45
  v_and_b32 v46, s53, v46
  v_and_b32 v47, s53, v47
  v_and_b32 v48, s53, v48
  v_and_b32 v49, s53, v49
  v_and_b32 v50, s53, v50
  v_and_b32 v51, s53, v51
  v_and_b32 v52, s53, v52
  v_and_b32 v53, s53, v53
  v_and_b32 v54, s53, v54
  v_and_b32 v55, s53, v55
  v_add_f32 v20, v20, v24
  v_add_f32 v21, v21, v25
  v_add_f32 v22, v22, v26
  v_add_f32 v23, v23, v27
  v_add_f32 v28, v28, v32
  v_add_f32 v29, v29, v33
  v_add_f32 v30, v30, v34
  v_add_f32 v31, v31, v35
  v_add_f32 v36, v36, v40
  v_add_f32 v37, v37, v41
  v_add_f32 v38, v38, v42
  v_add_f32 v39, v39, v43
  v_add_f32 v44, v44, v48
  v_add_f32 v45, v45, v49
  v_add_f32 v46, v46, v50
  v_add_f32 v47, v47, v51
  v_add_f32 v20, v20, v28
  v_add_f32 v21, v21, v29
  v_add_f32 v22, v22, v30
  v_add_f32 v23, v23, v31
  v_add_f32 v36, v36, v44
  v_add_f32 v37, v37, v45
  v_add_f32 v38, v38, v46
  v_add_f32 v39, v39, v47
  v_add_f32 v20, v20, v36
  v_add_f32 v21, v21, v37
  v_add_f32 v22, v22, v38
  v_add_f32 v23, v23, v39
  v_add_f32 v104, v20, v52
  v_add_f32 v105, v21, v53
  v_add_f32 v106, v22, v54
  v_add_f32 v107, v23, v55
  s_nop 1
  v_add_f32_dpp v104, v104, v104 row_ror:8 row_mask:0xf bank_mask:0xf
  v_add_f32_dpp v105, v105, v105 row_ror:8 row_mask:0xf bank_mask:0xf
  v_add_f32_dpp v106, v106, v106 row_ror:8 row_mask:0xf bank_mask:0xf
  v_add_f32_dpp v107, v107, v107 row_ror:8 row_mask:0xf bank_mask:0xf
  v_mov_b32 v108, v104
  v_mov_b32 v109, v105
  v_mov_b32 v110, v106
  v_mov_b32 v111, v107
  s_nop 1
  v_permlane16_swap_b32 v104, v108
  v_permlane16_swap_b32 v105, v109
  v_permlane16_swap_b32 v106, v110
  v_permlane16_swap_b32 v107, v111
  s_nop 1
  v_add_f32 v104, v104, v108
  v_add_f32 v105, v105, v109
  v_add_f32 v106, v106, v110
  v_add_f32 v107, v107, v111
  v_mov_b32 v108, v104
  v_mov_b32 v109, v105
  v_mov_b32 v110, v106
  v_mov_b32 v111, v107
  s_nop 1
  v_permlane32_swap_b32 v104, v108
  v_permlane32_swap_b32 v105, v109
  v_permlane32_swap_b32 v106, v110
  v_permlane32_swap_b32 v107, v111
  s_nop 1
  v_add_f32 v104, v104, v108
  v_add_f32 v105, v105, v109
  v_add_f32 v106, v106, v110
  v_add_f32 v107, v107, v111
  s_lshl_b32 s51, s71, 7
  v_add_u32 v14, s51, v8
  v_add_u32 v14, 162160, v14
  s_mov_b64 exec, 0xff
  ds_write_b128 v14, v[104:107]
  s_mov_b64 exec, -1
  s_mov_b64 exec, 1
  ds_add_rtn_u32 v15, v1, v2 offset:40
  s_mov_b64 exec, -1
  s_waitcnt lgkmcnt(0)
  v_readfirstlane_b32 s51, v15
  s_cmp_lg_u32 s51, 3
  s_cbranch_scc1 Lrede_134
  ds_read2_b32 v[112:113], v12 offset0:0 offset1:4
  ds_read2_b32 v[114:115], v12 offset0:32 offset1:36
  ds_read2_b32 v[116:117], v12 offset0:64 offset1:68
  ds_read2_b32 v[118:119], v12 offset0:96 offset1:100
  s_waitcnt lgkmcnt(0)
  v_add_f32 v112, v112, v114
  v_add_f32 v113, v113, v115
  v_add_f32 v116, v116, v118
  v_add_f32 v117, v117, v119
  v_add_f32 v112, v112, v116
  v_add_f32 v113, v113, v117
  s_waitcnt vmcnt(0)
  v_lshlrev_b32 v114, 16, v13
  v_and_b32 v115, 0xffff0000, v13
  v_add_f32 v112, v112, v114
  v_add_f32 v113, v113, v115
  v_cvt_pk_bf16_f32 v112, v112, v113
  s_mov_b64 exec, 0xffff
  buffer_store_dword v112, v11, s[64:67], 0 offen
  s_mov_b64 exec, 1
  s_cmp_lg_u32 s2, 0
  s_cbranch_scc1 Lep_138
  v_mov_b32 v120, s42
  v_mov_b32 v121, 0
  buffer_store_dword v120, v121, s[44:47], 0 offen sc1
Lep_138:
  s_mov_b64 exec, -1
Lrede_134:
  s_endpgm
Lend:
  s_endpgm
.section .rodata,"a"
.p2align 6
.amdhsa_kernel parallel_sum__sliding_block_cached__glu_gated_reglu__decode_kernel
  .amdhsa_next_free_vgpr 168
  .amdhsa_next_free_sgpr 102
  .amdhsa_accum_offset 168
  .amdhsa_group_segment_fixed_size 0
  .amdhsa_kernarg_size 96
  .amdhsa_user_sgpr_count 2
  .amdhsa_user_sgpr_kernarg_segment_ptr 1
  .amdhsa_system_sgpr_workgroup_id_x 1
  .amdhsa_float_denorm_mode_32 3
.end_amdhsa_kernel
```
